```python
import torch

def _softmax(x, axis=-1):
    return torch.softmax(x, dim=axis)

def _gelu(x):
    return torch.nn.functional.gelu(x, approximate='tanh')

def _silu(x):
    return torch.nn.functional.silu(x)

def _sigmoid(x):
    return torch.sigmoid(x)

def _layernorm(x, axis=-1, eps=1e-05):
    m = x.mean(dim=axis, keepdim=True)
    v = x.var(dim=axis, keepdim=True, unbiased=False)
    return (x - m) / torch.sqrt(v + eps)

def _scatter_add(tgt, idx, src, axis=0):
    return tgt.clone().index_add_(axis, idx, src)

def _segment_sum(src, seg, n):
    out = torch.zeros((n,) + src.shape[1:], dtype=src.dtype)
    return out.index_add_(0, seg, src)

def _pad(x, pw):
    flat = tuple((v for pair in reversed(pw) for v in pair))
    return torch.nn.functional.pad(x, flat)
kernel_name = 'adaLN_cond__compressed_kv_cla__glu_gated_geglu__decode'

def setup_inputs():

    _w = lambda a: (lambda t: t.to(torch.bfloat16) if t.is_floating_point() else t)(torch.as_tensor(a))

    def _A_setup():
        B, H, Sq, Sk, D, M = (2, 32, 1, 8192, 128, 512)
        Dc = 4 * D
        return {'x': _w((lambda *s: torch.randn(*s, dtype=torch.bfloat16) * 0.05)(B, Sq, M)), 'c_kv': _w((lambda *s: torch.randn(*s, dtype=torch.bfloat16) * 3.2)(B, Sk, Dc)), 'w_q': _w((lambda *s: torch.randn(*s, dtype=torch.bfloat16) * 0.8)(M, H, D) * M ** (-0.5)), 'w_uk': _w((lambda *s: torch.randn(*s, dtype=torch.bfloat16) * 0.8)(Dc, H, D) * Dc ** (-0.5)), 'w_uv': _w((lambda *s: torch.randn(*s, dtype=torch.bfloat16) * 3.2)(Dc, H, D) * Dc ** (-0.5)), 'w_o': _w((lambda *s: torch.randn(*s, dtype=torch.bfloat16) * 3.2)(H, D, M) * (H * D) ** (-0.5))}
    _A_in = _A_setup()

    def _B_setup():
        B, S, Dm, Df = (2, 1, 512, 1792)
        return {'x': _w((lambda *s: torch.randn(*s, dtype=torch.bfloat16) * 0.05)(B, S, Dm)), 'w_gate': _w((lambda *s: torch.randn(*s, dtype=torch.bfloat16) * 3.2)(Dm, Df) * Dm ** (-0.5)), 'w_up': _w((lambda *s: torch.randn(*s, dtype=torch.bfloat16) * 3.2)(Dm, Df) * Dm ** (-0.5)), 'w_down': _w((lambda *s: torch.randn(*s, dtype=torch.bfloat16) * 3.2)(Df, Dm) * Df ** (-0.5))}
    _B_in = _B_setup()
    return {'A_x': _A_in['x'], 'A_c_kv': _A_in['c_kv'], 'A_w_q': _A_in['w_q'], 'A_w_uk': _A_in['w_uk'], 'A_w_uv': _A_in['w_uv'], 'A_w_o': _A_in['w_o'], 'B_x': _B_in['x'], 'B_w_gate': _B_in['w_gate'], 'B_w_up': _B_in['w_up'], 'B_w_down': _B_in['w_down'], 'c': _w((lambda *s: torch.randn(*s, dtype=torch.bfloat16) * 0.1)(2, 512) * 8.0), 'w_mod': _w((lambda *s: torch.randn(*s, dtype=torch.bfloat16) * 0.1)(512, 6 * 512) * 512 ** (-0.5) * 8.0)}

def reference(A_x, A_c_kv, A_w_q, A_w_uk, A_w_uv, A_w_o, B_x, B_w_gate, B_w_up, B_w_down, c, w_mod):

    def _A_ref(x, c_kv, w_q, w_uk, w_uv, w_o):
        B, Sq, M = (x.shape[0], x.shape[1], x.shape[2])
        Sk = c_kv.shape[1]
        H, D = (w_q.shape[1], w_q.shape[2])
        q = torch.einsum('bqm,mhd->bhqd', x, w_q)
        k = torch.einsum('bkc,chd->bhkd', c_kv, w_uk)
        v = torch.einsum('bkc,chd->bhkd', c_kv, w_uv)
        scores = torch.einsum('bhqd,bhkd->bhqk', q, k) * D ** (-0.5)
        off = Sk - Sq
        qi = torch.arange(Sq)[:, None]
        kj = torch.arange(Sk)[None, :]
        cmask = kj <= qi + off
        scores = torch.where(cmask[None, None], scores, -1000000000.0)
        p = _softmax(scores, axis=-1)
        ctx = torch.einsum('bhqk,bhkd->bhqd', p, v)
        return torch.einsum('bhqd,hdm->bqm', ctx, w_o)

    def _B_ref(x, w_gate, w_up, w_down):
        g = torch.einsum('bsd,df->bsf', x, w_gate)
        u = torch.einsum('bsd,df->bsf', x, w_up)
        h = _gelu(g) * u
        return torch.einsum('bsf,fd->bsd', h, w_down)
    x = A_x
    mod = (_silu(c) @ w_mod).reshape(c.shape[0], 6, 1, -1)
    sa, ca, ga, sb, cb, gb = (mod[:, 0].clone(), mod[:, 1].clone(), mod[:, 2].clone(), mod[:, 3].clone(), mod[:, 4].clone(), mod[:, 5].clone())
    h = _layernorm(x, axis=-1) * (1 + ca) + sa
    x = x + ga * _A_ref(h, A_c_kv, A_w_q, A_w_uk, A_w_uv, A_w_o)
    h = _layernorm(x, axis=-1) * (1 + cb) + sb
    x = x + gb * _B_ref(h, B_w_gate, B_w_up, B_w_down)
    return x
```

```asm
; @launch grid=(256,1,1) block=(512,1,1) lds=163840
.amdgcn_target "amdgcn-amd-amdhsa--gfx950"
.text
.globl adaLN_cond__compressed_kv_cla__glu_gated_geglu__decode_kernel
.p2align 8
.type adaLN_cond__compressed_kv_cla__glu_gated_geglu__decode_kernel,@function
adaLN_cond__compressed_kv_cla__glu_gated_geglu__decode_kernel:
  s_cmp_ge_u32 s2, 256
  s_cbranch_scc1 L_END
  s_load_dwordx16 s[8:23], s[0:1], 0
  s_load_dwordx8 s[24:31], s[0:1], 64
  s_load_dwordx4 s[32:35], s[0:1], 96
  s_load_dwordx2 s[36:37], s[0:1], 112
  s_memrealtime s[100:101]
  s_getpc_b64 s[44:45]
  v_and_b32 v1, 63, v0
  v_lshrrev_b32 v8, 6, v0
  v_and_b32 v2, 15, v0
  v_readfirstlane_b32 s3, v8
  v_bfe_u32 v3, v0, 4, 2
  v_and_b32 v4, 31, v0
  v_bfe_u32 v5, v0, 5, 1
  v_lshlrev_b32 v6, 4, v1
  v_lshlrev_b32 v7, 3, v1
  s_and_b32 s4, s2, 7
  s_lshr_b32 s5, s2, 3
  v_add_u32 v253, 161792, v6
  s_and_b32 s44, s44, 0xffffff00
  s_sub_u32 s6, s5, 12
  s_cmp_ge_u32 s6, 4
  s_cbranch_scc1 L_NOPF
  s_sub_u32 s7, s3, 2
  s_cmp_ge_u32 s7, 6
  s_cbranch_scc1 L_NOPF
  s_mul_i32 s6, s6, 6
  s_add_u32 s6, s6, s7
  s_add_u32 s6, s6, 1
  s_cmp_ge_u32 s6, 18
  s_cbranch_scc1 L_NOPF
  s_lshl_b32 s6, s6, 10
  v_add_u32 v8, s6, v6
  global_load_dwordx4 v[240:243], v8, s[44:45]
  s_nop 0
L_NOPF:
  s_mov_b32 s48, 0x00030003
  s_mov_b32 s49, 0x00030003
  s_mov_b32 s50, 0x00110011
  s_mov_b32 s51, 0x00110011
  s_lshr_b32 s60, s3, 2
  s_and_b32 s55, s3, 3
  s_lshr_b32 s61, s3, 1
  s_and_b32 s62, s3, 1
  s_bfe_u32 s6, s5, 0x20002
  s_lshl_b32 s40, s4, 2
  s_add_u32 s40, s40, s6
  s_and_b32 s41, s5, 3
  s_cmp_lg_u32 s2, 64
  s_cbranch_scc1 L_ep_1
  s_cmp_lg_u32 s3, 0
  s_cbranch_scc1 L_ep_1
  s_waitcnt lgkmcnt(0)
  s_or_b32 s100, s100, 1
  v_mov_b32 v10, s100
  v_mov_b32 v11, s101
  v_mov_b32 v8, 0
  s_mov_b64 exec, 1
  global_store_dwordx2 v8, v[10:11], s[34:35] sc1
  s_mov_b64 exec, -1
L_ep_1:
  s_and_b32 s5, s5, 15
  s_and_b32 s96, s2, 127
  s_cmp_ge_u32 s2, 128
  s_cbranch_scc1 L_ROLE_A
  s_mov_b32 s38, s2
  s_lshr_b32 s39, s38, 6
  s_and_b32 s42, s38, 63
  v_mov_b32 v16, -1
  v_mov_b32 v17, -1
  v_mov_b32 v18, -1
  v_mov_b32 v19, -1
  s_lshl_b32 s6, s55, 4
  v_xor_b32 v20, s6, v6
  v_xor_b32 v21, 64, v20
  v_xor_b32 v22, 128, v20
  v_xor_b32 v23, 192, v20
  s_mul_i32 s52, s3, 4096
  s_mov_b32 s43, s38
  s_cmp_ge_u32 s43, 64
  s_cbranch_scc1 L_cl_3
  s_lshr_b32 s56, s43, 4
  s_and_b32 s57, s43, 15
  v_and_b32 v8, 1, v2
  v_lshlrev_b32 v8, 10, v8
  v_lshl_add_u32 v8, v3, 3, v8
  s_mul_i32 s6, s56, 256
  s_mul_i32 s7, s3, 32
  s_add_u32 s6, s6, s7
  v_add_u32 v8, s6, v8
  v_lshlrev_b32 v11, 1, v3
  v_and_b32 v9, 7, v1
  v_xor_b32 v11, v11, v9
  v_lshlrev_b32 v11, 4, v11
  v_lshrrev_b32 v9, 3, v1
  s_mov_b32 s6, 6144
  v_mul_lo_u32 v9, v9, s6
  v_add_u32 v11, v11, v9
  s_mul_i32 s53, s3, 2048
  s_add_u32 s53, s53, 131072
  s_mul_i32 s6, s56, 786432
  s_mul_i32 s7, s3, 98304
  s_add_u32 s6, s6, s7
  s_mul_i32 s7, s57, 128
  s_add_u32 s6, s6, s7
  s_waitcnt lgkmcnt(0)
  s_add_u32 s44, s30, s6
  s_addc_u32 s45, s31, 0
  global_load_dwordx2 v[24:25], v8, s[28:29]
  s_add_u32 m0, s53, 0
  s_nop 0
  global_load_lds_dwordx4 v11, s[44:45] nt
  v_add_u32 v11, 49152, v11
  s_add_u32 m0, s53, 1024
  s_nop 0
  global_load_lds_dwordx4 v11, s[44:45] nt
  s_mul_i32 s6, s39, 8388608
  s_mul_i32 s7, s42, 4096
  s_add_u32 s6, s6, s7
  s_mul_i32 s7, s3, 262144
  s_add_u32 s6, s6, s7
  s_add_u32 s94, s10, s6
  s_addc_u32 s95, s11, 0
  s_branch L_CONT_1
L_cl_3:
  s_mul_i32 s6, s39, 8388608
  s_mul_i32 s7, s42, 4096
  s_add_u32 s6, s6, s7
  s_mul_i32 s7, s3, 262144
  s_add_u32 s6, s6, s7
  s_waitcnt lgkmcnt(0)
  s_add_u32 s94, s10, s6
  s_addc_u32 s95, s11, 0
  s_cmp_ge_u32 s43, 96
  s_cbranch_scc1 L_nc_2
  s_sub_u32 s43, s43, 64
  s_mul_i32 s6, s43, 16384
  s_mul_i32 s7, s3, 2048
  s_add_u32 s6, s6, s7
  s_add_u32 s6, s6, 131072
  s_add_u32 s44, s36, s6
  s_addc_u32 s45, s37, 0
  global_store_dwordx4 v6, v[16:19], s[44:45] offset:0 sc1
  global_store_dwordx4 v6, v[16:19], s[44:45] offset:1024 sc1
  s_mul_i32 s6, s43, 2048
  s_mul_i32 s7, s3, 256
  s_add_u32 s6, s6, s7
  s_add_u32 s6, s6, 65536
  s_add_u32 s44, s36, s6
  s_addc_u32 s45, s37, 0
  s_mov_b64 exec, 0xffff
  global_store_dwordx4 v6, v[16:19], s[44:45] sc1
  s_mov_b64 exec, -1
  s_waitcnt vmcnt(0)
  s_waitcnt lgkmcnt(0)
  s_barrier
  s_cmp_lg_u32 s3, 0
  s_cbranch_scc1 L_c1_7
  v_mov_b32 v8, 0
  v_mov_b32 v9, 1
  s_mov_b64 exec, 1
  global_atomic_add v10, v8, v9, s[34:35] offset:192 sc0 sc1
  s_waitcnt vmcnt(0)
  s_mov_b64 exec, -1
  v_readfirstlane_b32 s6, v10
  s_nop 3
  s_cmp_lg_u32 s6, 31
  s_cbranch_scc1 L_c1_7
  v_mov_b32 v9, 0x01010101
  s_mov_b64 exec, 1
  global_store_dword v8, v9, s[34:35] offset:128 sc1
  s_mov_b64 exec, -1
L_c1_7:
  s_sleep 10
  s_branch L_MODDONE
L_nc_2:
  s_sleep 35
L_MODDONE:
  s_add_u32 m0, s52, 0
  s_nop 0
  global_load_lds_dwordx4 v20, s[94:95] offset:0 nt
  s_add_u32 m0, s52, 0
  s_nop 0
  global_load_lds_dwordx4 v21, s[94:95] offset:1024 nt
  s_add_u32 m0, s52, 0
  s_nop 0
  global_load_lds_dwordx4 v22, s[94:95] offset:2048 nt
  s_add_u32 m0, s52, 0
  s_nop 0
  global_load_lds_dwordx4 v23, s[94:95] offset:3072 nt
  s_branch L_CONT_2
L_ROLE_A:
  s_mov_b32 s6, 8192
  v_mul_lo_u32 v9, v3, s6
  v_lshlrev_b32 v11, 1, v3
  v_xor_b32 v11, v11, v2
  v_lshl_add_u32 v11, v11, 4, v9
  s_mul_i32 s53, s3, 4096
  s_mul_i32 s6, s41, 1048576
  s_mul_i32 s7, s3, 131072
  s_add_u32 s6, s6, s7
  s_mul_i32 s7, s40, 256
  s_add_u32 s6, s6, s7
  s_waitcnt lgkmcnt(0)
  s_add_u32 s44, s12, s6
  s_addc_u32 s45, s13, 0
  s_add_u32 m0, s53, 0
  s_nop 0
  global_load_lds_dwordx4 v11, s[44:45] nt
  v_xor_b32 v12, 128, v11
  v_add_u32 v12, 32768, v12
  s_add_u32 m0, s53, 1024
  s_nop 0
  global_load_lds_dwordx4 v12, s[44:45] nt
  v_xor_b32 v12, 0, v11
  v_add_u32 v12, 65536, v12
  s_add_u32 m0, s53, 2048
  s_nop 0
  global_load_lds_dwordx4 v12, s[44:45] nt
  v_xor_b32 v12, 128, v11
  v_add_u32 v12, 98304, v12
  s_add_u32 m0, s53, 3072
  s_nop 0
  global_load_lds_dwordx4 v12, s[44:45] nt
  s_cmp_lg_u32 s3, 0
  s_cbranch_scc1 L_xl_29
  v_lshlrev_b32 v9, 5, v1
  global_load_dwordx4 v[64:67], v9, s[8:9]
  global_load_dwordx4 v[68:71], v9, s[8:9] offset:16
  v_lshlrev_b32 v10, 10, v5
  v_lshl_add_u32 v10, v4, 3, v10
  s_lshl_b32 s6, s41, 8
  v_add_u32 v10, s6, v10
  global_load_dwordx2 v[18:19], v10, s[8:9]
  s_nop 0
L_xl_29:
  s_branch L_CONT_3
L_CONT_1:
  v_lshrrev_b32 v9, 2, v2
  v_lshl_add_u32 v9, v3, 2, v9
  v_bfe_u32 v12, v9, 1, 2
  v_lshlrev_b32 v12, 5, v12
  v_lshl_add_u32 v12, v9, 7, v12
  v_and_b32 v9, 3, v2
  v_lshl_add_u32 v12, v9, 3, v12
  s_mul_i32 s6, s3, 2048
  s_add_u32 s6, s6, 131072
  v_add_u32 v12, s6, v12
  v_lshlrev_b32 v14, 6, v2
  v_lshl_add_u32 v14, v3, 4, v14
  s_mul_i32 s6, s3, 512
  s_add_u32 s6, s6, 100352
  v_add_u32 v14, s6, v14
  v_lshrrev_b32 v15, 1, v2
  v_lshlrev_b32 v15, 9, v15
  v_and_b32 v10, 1, v2
  v_lshl_add_u32 v15, v10, 6, v15
  v_lshl_add_u32 v15, v3, 4, v15
  s_mul_i32 s6, s55, 128
  s_add_u32 s6, s6, 100352
  v_add_u32 v15, s6, v15
  v_lshlrev_b32 v26, 12, v10
  v_lshl_add_u32 v26, v3, 4, v26
  s_mul_i32 s6, s56, 8192
  s_mul_i32 s7, s57, 256
  s_add_u32 s6, s6, s7
  s_mul_i32 s7, s55, 64
  s_add_u32 s6, s6, s7
  s_add_u32 s46, s36, s6
  s_addc_u32 s47, s37, 0
  v_mov_b32 v27, 0
  s_waitcnt vmcnt(2)
  v_lshlrev_b32 v28, 16, v24
  v_and_b32 v29, 0xffff0000, v24
  v_lshlrev_b32 v30, 16, v25
  v_and_b32 v31, 0xffff0000, v25
  s_mov_b32 s6, 0xbfb8aa3b
  v_mul_f32 v48, s6, v28
  v_mul_f32 v49, s6, v29
  v_mul_f32 v50, s6, v30
  v_mul_f32 v51, s6, v31
  v_exp_f32 v48, v48
  v_exp_f32 v49, v49
  v_exp_f32 v50, v50
  v_exp_f32 v51, v51
  v_add_f32 v48, 1.0, v48
  v_add_f32 v49, 1.0, v49
  v_add_f32 v50, 1.0, v50
  v_add_f32 v51, 1.0, v51
  v_rcp_f32 v48, v48
  v_rcp_f32 v49, v49
  v_rcp_f32 v50, v50
  v_rcp_f32 v51, v51
  v_mul_f32 v28, v28, v48
  v_mul_f32 v29, v29, v49
  v_mul_f32 v30, v30, v50
  v_mul_f32 v31, v31, v51
  v_cvt_pk_bf16_f32 v48, v28, v29
  v_cvt_pk_bf16_f32 v49, v30, v31
  global_load_dwordx2 v[90:91], v27, s[34:35] sc1
  s_waitcnt vmcnt(1)
  v_xor_b32 v8, 0, v12
  ds_read_b64_tr_b16 v[56:57], v8
  v_xor_b32 v9, 32, v12
  ds_read_b64_tr_b16 v[58:59], v9
  v_xor_b32 v10, 64, v12
  ds_read_b64_tr_b16 v[60:61], v10
  v_xor_b32 v11, 96, v12
  ds_read_b64_tr_b16 v[62:63], v11
  s_waitcnt lgkmcnt(3)
  v_mfma_f32_16x16x16_bf16 v[72:75], v[56:57], v[48:49], 0
  s_waitcnt lgkmcnt(2)
  v_mfma_f32_16x16x16_bf16 v[76:79], v[58:59], v[48:49], 0
  s_waitcnt lgkmcnt(1)
  v_mfma_f32_16x16x16_bf16 v[80:83], v[60:61], v[48:49], 0
  s_waitcnt lgkmcnt(0)
  v_mfma_f32_16x16x16_bf16 v[84:87], v[62:63], v[48:49], 0
  s_lshl_b64 exec, s[48:49], 2
  s_nop 2
  v_mov_b64 v[72:73], v[76:77]
  v_mov_b64 v[74:75], v[78:79]
  s_lshl_b64 exec, s[48:49], 4
  v_mov_b64 v[72:73], v[80:81]
  v_mov_b64 v[74:75], v[82:83]
  s_lshl_b64 exec, s[48:49], 6
  v_mov_b64 v[72:73], v[84:85]
  v_mov_b64 v[74:75], v[86:87]
  s_mov_b32 exec_lo, 0x00ff00ff
  s_mov_b32 exec_hi, 0x00ff00ff
  ds_write_b128 v14, v[72:75]
  s_mov_b64 exec, -1
  s_waitcnt lgkmcnt(0)
  s_barrier
  s_cmp_ge_u32 s3, 4
  s_cbranch_scc1 L_mw_4
  ds_read_b128 v[72:75], v15
  s_waitcnt lgkmcnt(0)
  v_add_f32_dpp v72, v72, v72 row_ror:8 row_mask:0xf bank_mask:0xf
  v_add_f32_dpp v73, v73, v73 row_ror:8 row_mask:0xf bank_mask:0xf
  v_add_f32_dpp v74, v74, v74 row_ror:8 row_mask:0xf bank_mask:0xf
  v_add_f32_dpp v75, v75, v75 row_ror:8 row_mask:0xf bank_mask:0xf
  v_add_f32_dpp v72, v72, v72 row_ror:4 row_mask:0xf bank_mask:0xf
  v_add_f32_dpp v73, v73, v73 row_ror:4 row_mask:0xf bank_mask:0xf
  v_add_f32_dpp v74, v74, v74 row_ror:4 row_mask:0xf bank_mask:0xf
  v_add_f32_dpp v75, v75, v75 row_ror:4 row_mask:0xf bank_mask:0xf
  v_add_f32_dpp v72, v72, v72 row_ror:2 row_mask:0xf bank_mask:0xf
  v_add_f32_dpp v73, v73, v73 row_ror:2 row_mask:0xf bank_mask:0xf
  v_add_f32_dpp v74, v74, v74 row_ror:2 row_mask:0xf bank_mask:0xf
  v_add_f32_dpp v75, v75, v75 row_ror:2 row_mask:0xf bank_mask:0xf
  v_cvt_pk_bf16_f32 v88, v72, v73
  v_cvt_pk_bf16_f32 v89, v74, v75
  s_mov_b32 s54, 60000
  s_waitcnt vmcnt(0)
L_epl_5:
  v_cmp_eq_u32 vcc, 0, v90
  s_cbranch_vccz L_epd_6
  s_sleep 2
  global_load_dwordx2 v[90:91], v27, s[34:35] sc1
  s_waitcnt vmcnt(0)
  s_sub_u32 s54, s54, 1
  s_cbranch_scc0 L_epl_5
L_epd_6:
  s_mov_b64 exec, s[48:49]
  global_store_dwordx4 v26, v[88:91], s[46:47] sc1
  s_mov_b64 exec, -1
  s_nop 0
L_mw_4:
  s_add_u32 m0, s52, 0
  s_nop 0
  global_load_lds_dwordx4 v20, s[94:95] offset:0 nt
  s_add_u32 m0, s52, 0
  s_nop 0
  global_load_lds_dwordx4 v21, s[94:95] offset:1024 nt
  s_add_u32 m0, s52, 0
  s_nop 0
  global_load_lds_dwordx4 v22, s[94:95] offset:2048 nt
  s_add_u32 m0, s52, 0
  s_nop 0
  global_load_lds_dwordx4 v23, s[94:95] offset:3072 nt
  s_branch L_CKVGO
L_CONT_2:
L_CKVGO:
  s_mov_b32 s53, s52
  v_and_b32 v8, 3, v2
  v_xor_b32 v8, v8, v3
  v_lshlrev_b32 v8, 2, v8
  v_lshrrev_b32 v9, 2, v2
  v_or_b32 v8, v8, v9
  v_lshlrev_b32 v8, 4, v8
  v_lshl_add_u32 v24, v2, 10, v8
  s_lshl_b32 s6, s55, 15
  v_add_u32 v25, s6, v24
  s_mul_i32 s6, s60, 16384
  s_add_u32 s6, s6, 131072
  v_add_u32 v24, s6, v24
  v_lshrrev_b32 v8, 2, v2
  v_lshl_add_u32 v9, v5, 2, v8
  v_lshl_or_b32 v8, v8, 2, v5
  v_and_b32 v10, 1, v3
  v_lshlrev_b32 v10, 1, v10
  v_bfe_u32 v11, v2, 1, 1
  v_or_b32 v10, v10, v11
  s_lshl_b32 s6, s62, 3
  v_or_b32 v10, s6, v10
  v_xor_b32 v10, v10, v8
  v_lshlrev_b32 v10, 4, v10
  v_lshl_add_u32 v10, v9, 10, v10
  v_and_b32 v11, 1, v2
  v_lshl_add_u32 v10, v11, 3, v10
  s_lshl_b32 s6, s61, 8
  v_add_u32 v10, s6, v10
  v_xor_b32 v26, 0, v10
  v_xor_b32 v27, 32, v10
  v_add_u32 v27, 8192, v27
  v_xor_b32 v28, 64, v10
  v_xor_b32 v29, 96, v10
  v_add_u32 v29, 8192, v29
  s_mul_i32 s6, s39, 32768
  s_mul_i32 s7, s3, 4096
  s_add_u32 s6, s6, s7
  s_add_u32 s6, s6, 131072
  s_add_u32 s44, s36, s6
  s_addc_u32 s45, s37, 0
  s_waitcnt vmcnt(3)
  s_add_u32 s94, s94, 2097152
  s_addc_u32 s95, s95, 0
  s_add_u32 m0, s52, 32768
  s_nop 0
  global_load_lds_dwordx4 v20, s[94:95] offset:0 nt
  s_waitcnt vmcnt(3)
  s_add_u32 m0, s52, 32768
  s_nop 0
  global_load_lds_dwordx4 v21, s[94:95] offset:1024 nt
  s_waitcnt vmcnt(3)
  s_add_u32 m0, s52, 32768
  s_nop 0
  global_load_lds_dwordx4 v22, s[94:95] offset:2048 nt
  s_waitcnt vmcnt(3)
  s_add_u32 m0, s52, 32768
  s_nop 0
  global_load_lds_dwordx4 v23, s[94:95] offset:3072 nt
  s_waitcnt lgkmcnt(0)
  s_barrier
  s_cmp_lg_u32 s55, 0
  s_cbranch_scc1 L_qa_8
  v_xor_b32 v8, 0, v25
  ds_read_b128 v[32:35], v8 offset:0
  ds_read_b128 v[36:39], v8 offset:16384
  ds_read_b128 v[64:67], v8 offset:256
  ds_read_b128 v[68:71], v8 offset:16640
  ds_read_b128 v[96:99], v8 offset:512
  ds_read_b128 v[100:103], v8 offset:16896
  ds_read_b128 v[128:131], v8 offset:768
  ds_read_b128 v[132:135], v8 offset:17152
  v_xor_b32 v9, 16, v25
  ds_read_b128 v[40:43], v9 offset:0
  ds_read_b128 v[44:47], v9 offset:16384
  ds_read_b128 v[72:75], v9 offset:256
  ds_read_b128 v[76:79], v9 offset:16640
  ds_read_b128 v[104:107], v9 offset:512
  ds_read_b128 v[108:111], v9 offset:16896
  ds_read_b128 v[136:139], v9 offset:768
  ds_read_b128 v[140:143], v9 offset:17152
  v_xor_b32 v8, 32, v25
  ds_read_b128 v[48:51], v8 offset:0
  ds_read_b128 v[52:55], v8 offset:16384
  ds_read_b128 v[80:83], v8 offset:256
  ds_read_b128 v[84:87], v8 offset:16640
  ds_read_b128 v[112:115], v8 offset:512
  ds_read_b128 v[116:119], v8 offset:16896
  ds_read_b128 v[144:147], v8 offset:768
  ds_read_b128 v[148:151], v8 offset:17152
  v_xor_b32 v9, 48, v25
  ds_read_b128 v[56:59], v9 offset:0
  ds_read_b128 v[60:63], v9 offset:16384
  ds_read_b128 v[88:91], v9 offset:256
  ds_read_b128 v[92:95], v9 offset:16640
  ds_read_b128 v[120:123], v9 offset:512
  ds_read_b128 v[124:127], v9 offset:16896
  ds_read_b128 v[152:155], v9 offset:768
  ds_read_b128 v[156:159], v9 offset:17152
L_qa_8:
  ds_read_b64_tr_b16 v[160:161], v26 offset:0
  ds_read_b64_tr_b16 v[162:163], v26 offset:16384
  ds_read_b64_tr_b16 v[192:193], v28 offset:0
  ds_read_b64_tr_b16 v[194:195], v28 offset:16384
  ds_read_b64_tr_b16 v[164:165], v27 offset:0
  ds_read_b64_tr_b16 v[166:167], v27 offset:16384
  ds_read_b64_tr_b16 v[196:197], v29 offset:0
  ds_read_b64_tr_b16 v[198:199], v29 offset:16384
  s_waitcnt vmcnt(3)
  s_add_u32 s94, s94, 2097152
  s_addc_u32 s95, s95, 0
  s_add_u32 m0, s52, 65536
  s_nop 0
  global_load_lds_dwordx4 v20, s[94:95] offset:0 nt
  s_waitcnt vmcnt(3)
  s_add_u32 m0, s52, 65536
  s_nop 0
  global_load_lds_dwordx4 v21, s[94:95] offset:1024 nt
  s_waitcnt vmcnt(3)
  s_add_u32 m0, s52, 65536
  s_nop 0
  global_load_lds_dwordx4 v22, s[94:95] offset:2048 nt
  s_waitcnt vmcnt(3)
  s_add_u32 m0, s52, 65536
  s_nop 0
  global_load_lds_dwordx4 v23, s[94:95] offset:3072 nt
  s_waitcnt lgkmcnt(0)
  s_barrier
  s_cmp_lg_u32 s55, 1
  s_cbranch_scc1 L_qa_9
  v_xor_b32 v8, 0, v25
  ds_read_b128 v[32:35], v8 offset:0
  ds_read_b128 v[36:39], v8 offset:16384
  ds_read_b128 v[64:67], v8 offset:256
  ds_read_b128 v[68:71], v8 offset:16640
  ds_read_b128 v[96:99], v8 offset:512
  ds_read_b128 v[100:103], v8 offset:16896
  ds_read_b128 v[128:131], v8 offset:768
  ds_read_b128 v[132:135], v8 offset:17152
  v_xor_b32 v9, 16, v25
  ds_read_b128 v[40:43], v9 offset:0
  ds_read_b128 v[44:47], v9 offset:16384
  ds_read_b128 v[72:75], v9 offset:256
  ds_read_b128 v[76:79], v9 offset:16640
  ds_read_b128 v[104:107], v9 offset:512
  ds_read_b128 v[108:111], v9 offset:16896
  ds_read_b128 v[136:139], v9 offset:768
  ds_read_b128 v[140:143], v9 offset:17152
  v_xor_b32 v8, 32, v25
  ds_read_b128 v[48:51], v8 offset:0
  ds_read_b128 v[52:55], v8 offset:16384
  ds_read_b128 v[80:83], v8 offset:256
  ds_read_b128 v[84:87], v8 offset:16640
  ds_read_b128 v[112:115], v8 offset:512
  ds_read_b128 v[116:119], v8 offset:16896
  ds_read_b128 v[144:147], v8 offset:768
  ds_read_b128 v[148:151], v8 offset:17152
  v_xor_b32 v9, 48, v25
  ds_read_b128 v[56:59], v9 offset:0
  ds_read_b128 v[60:63], v9 offset:16384
  ds_read_b128 v[88:91], v9 offset:256
  ds_read_b128 v[92:95], v9 offset:16640
  ds_read_b128 v[120:123], v9 offset:512
  ds_read_b128 v[124:127], v9 offset:16896
  ds_read_b128 v[152:155], v9 offset:768
  ds_read_b128 v[156:159], v9 offset:17152
L_qa_9:
  ds_read_b64_tr_b16 v[168:169], v26 offset:32768
  ds_read_b64_tr_b16 v[170:171], v26 offset:49152
  ds_read_b64_tr_b16 v[200:201], v28 offset:32768
  ds_read_b64_tr_b16 v[202:203], v28 offset:49152
  ds_read_b64_tr_b16 v[172:173], v27 offset:32768
  ds_read_b64_tr_b16 v[174:175], v27 offset:49152
  ds_read_b64_tr_b16 v[204:205], v29 offset:32768
  ds_read_b64_tr_b16 v[206:207], v29 offset:49152
  v_add_u32 v26, 65536, v26
  v_add_u32 v27, 65536, v27
  v_add_u32 v28, 65536, v28
  v_add_u32 v29, 65536, v29
  s_waitcnt vmcnt(3)
  s_add_u32 s94, s94, 2097152
  s_addc_u32 s95, s95, 0
  s_add_u32 m0, s52, 98304
  s_nop 0
  global_load_lds_dwordx4 v20, s[94:95] offset:0 nt
  s_waitcnt vmcnt(3)
  s_add_u32 m0, s52, 98304
  s_nop 0
  global_load_lds_dwordx4 v21, s[94:95] offset:1024 nt
  s_waitcnt vmcnt(3)
  s_add_u32 m0, s52, 98304
  s_nop 0
  global_load_lds_dwordx4 v22, s[94:95] offset:2048 nt
  s_waitcnt vmcnt(3)
  s_add_u32 m0, s52, 98304
  s_nop 0
  global_load_lds_dwordx4 v23, s[94:95] offset:3072 nt
  v_mov_b32 v8, 128
  global_load_dword v17, v8, s[34:35] sc1
  s_waitcnt lgkmcnt(0)
  s_barrier
  s_cmp_lg_u32 s55, 2
  s_cbranch_scc1 L_qa_10
  v_xor_b32 v8, 0, v25
  ds_read_b128 v[32:35], v8 offset:0
  ds_read_b128 v[36:39], v8 offset:16384
  ds_read_b128 v[64:67], v8 offset:256
  ds_read_b128 v[68:71], v8 offset:16640
  ds_read_b128 v[96:99], v8 offset:512
  ds_read_b128 v[100:103], v8 offset:16896
  ds_read_b128 v[128:131], v8 offset:768
  ds_read_b128 v[132:135], v8 offset:17152
  v_xor_b32 v9, 16, v25
  ds_read_b128 v[40:43], v9 offset:0
  ds_read_b128 v[44:47], v9 offset:16384
  ds_read_b128 v[72:75], v9 offset:256
  ds_read_b128 v[76:79], v9 offset:16640
  ds_read_b128 v[104:107], v9 offset:512
  ds_read_b128 v[108:111], v9 offset:16896
  ds_read_b128 v[136:139], v9 offset:768
  ds_read_b128 v[140:143], v9 offset:17152
  v_xor_b32 v8, 32, v25
  ds_read_b128 v[48:51], v8 offset:0
  ds_read_b128 v[52:55], v8 offset:16384
  ds_read_b128 v[80:83], v8 offset:256
  ds_read_b128 v[84:87], v8 offset:16640
  ds_read_b128 v[112:115], v8 offset:512
  ds_read_b128 v[116:119], v8 offset:16896
  ds_read_b128 v[144:147], v8 offset:768
  ds_read_b128 v[148:151], v8 offset:17152
  v_xor_b32 v9, 48, v25
  ds_read_b128 v[56:59], v9 offset:0
  ds_read_b128 v[60:63], v9 offset:16384
  ds_read_b128 v[88:91], v9 offset:256
  ds_read_b128 v[92:95], v9 offset:16640
  ds_read_b128 v[120:123], v9 offset:512
  ds_read_b128 v[124:127], v9 offset:16896
  ds_read_b128 v[152:155], v9 offset:768
  ds_read_b128 v[156:159], v9 offset:17152
L_qa_10:
  ds_read_b64_tr_b16 v[176:177], v26 offset:0
  ds_read_b64_tr_b16 v[178:179], v26 offset:16384
  ds_read_b64_tr_b16 v[208:209], v28 offset:0
  ds_read_b64_tr_b16 v[210:211], v28 offset:16384
  ds_read_b64_tr_b16 v[180:181], v27 offset:0
  ds_read_b64_tr_b16 v[182:183], v27 offset:16384
  ds_read_b64_tr_b16 v[212:213], v29 offset:0
  ds_read_b64_tr_b16 v[214:215], v29 offset:16384
  s_waitcnt vmcnt(4)
  s_waitcnt vmcnt(3)
  s_waitcnt vmcnt(2)
  s_waitcnt vmcnt(1)
  s_waitcnt lgkmcnt(0)
  s_barrier
  s_mov_b32 s54, 60000
  s_mov_b32 s63, 0x01010101
  s_waitcnt vmcnt(0)
L_fl_11:
  v_cmp_ne_u32 vcc, s63, v17
  s_cbranch_vccz L_fld_12
  s_sleep 6
  v_mov_b32 v8, 128
  global_load_dword v17, v8, s[34:35] sc1
  s_waitcnt vmcnt(0)
  s_sub_u32 s54, s54, 1
  s_cbranch_scc0 L_fl_11
L_fld_12:
  s_cmp_lg_u32 s3, 0
  s_cbranch_scc1 L_gws_13
  s_mov_b32 s6, 425984
  s_add_u32 s98, s36, s6
  s_addc_u32 s99, s37, 0
  v_and_b32 v15, 7, v1
  v_lshlrev_b32 v15, 7, v15
  s_mov_b32 s54, 60000
  s_nop 0
L_go_15:
  global_load_dword v14, v15, s[98:99] sc1
  s_waitcnt vmcnt(0)
  v_cmp_eq_u32 vcc, -1, v14
  s_cbranch_vccz L_god_16
  s_sleep 2
  s_sub_u32 s54, s54, 1
  s_cbranch_scc0 L_go_15
L_god_16:
  v_mov_b32 v13, 60
  s_nop 1
L_gww_14:
  s_memrealtime s[100:101]
  s_waitcnt lgkmcnt(0)
  v_sub_u32 v15, s100, v14
  v_cmp_lt_u32 vcc, v15, v13
  s_cbranch_vccnz L_gww_14
  s_nop 3
L_gws_13:
  s_waitcnt lgkmcnt(0)
  s_barrier
  s_mov_b32 s54, 60000
  s_mul_i32 s63, s3, 4096
  s_add_u32 s63, s63, 131072
  s_mov_b32 m0, s63
  s_nop 0
  global_load_lds_dwordx4 v20, s[44:45] offset:0 sc1
  global_load_lds_dwordx4 v21, s[44:45] offset:1024 sc1
  global_load_lds_dwordx4 v22, s[44:45] offset:2048 sc1
  global_load_lds_dwordx4 v23, s[44:45] offset:3072 sc1
  s_cmp_lg_u32 s55, 3
  s_cbranch_scc1 L_qa_17
  v_xor_b32 v8, 0, v25
  ds_read_b128 v[32:35], v8 offset:0
  ds_read_b128 v[36:39], v8 offset:16384
  ds_read_b128 v[64:67], v8 offset:256
  ds_read_b128 v[68:71], v8 offset:16640
  ds_read_b128 v[96:99], v8 offset:512
  ds_read_b128 v[100:103], v8 offset:16896
  ds_read_b128 v[128:131], v8 offset:768
  ds_read_b128 v[132:135], v8 offset:17152
  v_xor_b32 v9, 16, v25
  ds_read_b128 v[40:43], v9 offset:0
  ds_read_b128 v[44:47], v9 offset:16384
  ds_read_b128 v[72:75], v9 offset:256
  ds_read_b128 v[76:79], v9 offset:16640
  ds_read_b128 v[104:107], v9 offset:512
  ds_read_b128 v[108:111], v9 offset:16896
  ds_read_b128 v[136:139], v9 offset:768
  ds_read_b128 v[140:143], v9 offset:17152
  v_xor_b32 v8, 32, v25
  ds_read_b128 v[48:51], v8 offset:0
  ds_read_b128 v[52:55], v8 offset:16384
  ds_read_b128 v[80:83], v8 offset:256
  ds_read_b128 v[84:87], v8 offset:16640
  ds_read_b128 v[112:115], v8 offset:512
  ds_read_b128 v[116:119], v8 offset:16896
  ds_read_b128 v[144:147], v8 offset:768
  ds_read_b128 v[148:151], v8 offset:17152
  v_xor_b32 v9, 48, v25
  ds_read_b128 v[56:59], v9 offset:0
  ds_read_b128 v[60:63], v9 offset:16384
  ds_read_b128 v[88:91], v9 offset:256
  ds_read_b128 v[92:95], v9 offset:16640
  ds_read_b128 v[120:123], v9 offset:512
  ds_read_b128 v[124:127], v9 offset:16896
  ds_read_b128 v[152:155], v9 offset:768
  ds_read_b128 v[156:159], v9 offset:17152
L_qa_17:
  ds_read_b64_tr_b16 v[184:185], v26 offset:32768
  ds_read_b64_tr_b16 v[186:187], v26 offset:49152
  ds_read_b64_tr_b16 v[216:217], v28 offset:32768
  ds_read_b64_tr_b16 v[218:219], v28 offset:49152
  ds_read_b64_tr_b16 v[188:189], v27 offset:32768
  ds_read_b64_tr_b16 v[190:191], v27 offset:49152
  ds_read_b64_tr_b16 v[220:221], v29 offset:32768
  ds_read_b64_tr_b16 v[222:223], v29 offset:49152
  s_branch L_H2W
L_H2R:
  s_mov_b32 m0, s63
  s_nop 0
  global_load_lds_dwordx4 v20, s[44:45] offset:0 sc1
  global_load_lds_dwordx4 v21, s[44:45] offset:1024 sc1
  global_load_lds_dwordx4 v22, s[44:45] offset:2048 sc1
  global_load_lds_dwordx4 v23, s[44:45] offset:3072 sc1
L_H2W:
  v_lshlrev_b32 v15, 4, v2
  s_lshl_b32 s6, s60, 8
  v_add_u32 v15, s6, v15
  s_lshl_b32 s6, s55, 2
  v_add_u32 v30, s6, v15
  v_xor_b32 v31, 256, v15
  v_mov_b32 v249, 0x7f800000
  v_lshrrev_b32 v252, 1, v3
  v_lshlrev_b32 v252, 10, v252
  v_and_b32 v13, 1, v3
  v_lshl_add_u32 v252, v13, 9, v252
  v_add_u32 v252, v252, v15
  s_lshl_b32 s6, s55, 11
  v_add_u32 v252, s6, v252
  s_waitcnt lgkmcnt(0)
  v_xor_b32 v8, 0, v24
  v_xor_b32 v14, 16, v24
  v_xor_b32 v10, 32, v24
  v_xor_b32 v11, 48, v24
  v_add_u32 v13, s63, v6
  s_waitcnt vmcnt(0)
  ds_read_b128 v[224:227], v13 offset:0
  ds_read_b128 v[228:231], v13 offset:1024
  ds_read_b128 v[232:235], v13 offset:2048
  ds_read_b128 v[236:239], v13 offset:3072
  s_waitcnt lgkmcnt(3)
  v_max3_u32 v248, v224, v225, v226
  v_max_u32 v248, v248, v227
  s_waitcnt lgkmcnt(2)
  v_max3_u32 v248, v248, v228, v229
  v_max3_u32 v248, v248, v230, v231
  s_waitcnt lgkmcnt(1)
  v_max3_u32 v248, v248, v232, v233
  v_max3_u32 v248, v248, v234, v235
  s_waitcnt lgkmcnt(0)
  v_max3_u32 v248, v248, v236, v237
  v_max3_u32 v248, v248, v238, v239
  v_cmp_eq_u32 vcc, -1, v248
  s_cbranch_vccz L_h2c_18
  s_sleep 8
  s_sub_u32 s54, s54, 1
  s_cbranch_scc0 L_H2R
L_h2c_18:
  s_waitcnt lgkmcnt(0)
  s_barrier
  ds_read_b128 v[224:227], v8 offset:0
  ds_read_b128 v[228:231], v14 offset:0
  ds_read_b128 v[232:235], v10 offset:0
  ds_read_b128 v[236:239], v11 offset:0
  ds_read_b128 v[16:19], v8 offset:256
  s_waitcnt lgkmcnt(4)
  v_mfma_f32_16x16x32_bf16 v[240:243], v[32:35], v[224:227], 0
  v_mfma_f32_16x16x32_bf16 v[244:247], v[36:39], v[224:227], 0
  ds_read_b128 v[224:227], v14 offset:256
  s_waitcnt lgkmcnt(4)
  v_mfma_f32_16x16x32_bf16 v[240:243], v[40:43], v[228:231], v[240:243]
  v_mfma_f32_16x16x32_bf16 v[244:247], v[44:47], v[228:231], v[244:247]
  ds_read_b128 v[228:231], v10 offset:256
  s_waitcnt lgkmcnt(4)
  v_mfma_f32_16x16x32_bf16 v[240:243], v[48:51], v[232:235], v[240:243]
  v_mfma_f32_16x16x32_bf16 v[244:247], v[52:55], v[232:235], v[244:247]
  ds_read_b128 v[232:235], v11 offset:256
  s_waitcnt lgkmcnt(4)
  v_mfma_f32_16x16x32_bf16 v[240:243], v[56:59], v[236:239], v[240:243]
  v_mfma_f32_16x16x32_bf16 v[244:247], v[60:63], v[236:239], v[244:247]
  ds_read_b128 v[236:239], v8 offset:512
  s_mul_i32 s6, s41, 1048576
  s_mul_i32 s7, s3, 131072
  s_add_u32 s6, s6, s7
  s_mul_i32 s7, s40, 256
  s_add_u32 s6, s6, s7
  s_add_u32 s56, s16, s6
  s_addc_u32 s57, s17, 0
  s_mov_b32 s6, 8192
  v_mul_lo_u32 v9, v3, s6
  v_lshlrev_b32 v12, 1, v3
  v_xor_b32 v12, v12, v2
  v_lshl_add_u32 v12, v12, 4, v9
  s_mul_i32 s53, s3, 4096
  s_add_u32 s53, s53, 32768
  s_add_u32 m0, s53, 0
  s_nop 0
  global_load_lds_dwordx4 v12, s[56:57] nt
  v_xor_b32 v13, 128, v12
  v_add_u32 v13, 32768, v13
  s_add_u32 m0, s53, 1024
  s_nop 0
  global_load_lds_dwordx4 v13, s[56:57] nt
  v_xor_b32 v13, 0, v12
  v_add_u32 v13, 65536, v13
  s_add_u32 m0, s53, 2048
  s_nop 0
  global_load_lds_dwordx4 v13, s[56:57] nt
  v_xor_b32 v13, 128, v12
  v_add_u32 v13, 98304, v13
  s_add_u32 m0, s53, 3072
  s_nop 0
  global_load_lds_dwordx4 v13, s[56:57] nt
  s_waitcnt lgkmcnt(4)
  v_mfma_f32_16x16x32_bf16 v[240:243], v[64:67], v[16:19], v[240:243]
  v_mfma_f32_16x16x32_bf16 v[244:247], v[68:71], v[16:19], v[244:247]
  ds_read_b128 v[16:19], v14 offset:512
  s_waitcnt lgkmcnt(4)
  v_mfma_f32_16x16x32_bf16 v[240:243], v[72:75], v[224:227], v[240:243]
  v_mfma_f32_16x16x32_bf16 v[244:247], v[76:79], v[224:227], v[244:247]
  ds_read_b128 v[224:227], v10 offset:512
  s_waitcnt lgkmcnt(4)
  v_mfma_f32_16x16x32_bf16 v[240:243], v[80:83], v[228:231], v[240:243]
  v_mfma_f32_16x16x32_bf16 v[244:247], v[84:87], v[228:231], v[244:247]
  ds_read_b128 v[228:231], v11 offset:512
  s_waitcnt lgkmcnt(4)
  v_mfma_f32_16x16x32_bf16 v[240:243], v[88:91], v[232:235], v[240:243]
  v_mfma_f32_16x16x32_bf16 v[244:247], v[92:95], v[232:235], v[244:247]
  ds_read_b128 v[232:235], v8 offset:768
  s_waitcnt lgkmcnt(4)
  v_mfma_f32_16x16x32_bf16 v[240:243], v[96:99], v[236:239], v[240:243]
  v_mfma_f32_16x16x32_bf16 v[244:247], v[100:103], v[236:239], v[244:247]
  ds_read_b128 v[236:239], v14 offset:768
  s_waitcnt lgkmcnt(4)
  v_mfma_f32_16x16x32_bf16 v[240:243], v[104:107], v[16:19], v[240:243]
  v_mfma_f32_16x16x32_bf16 v[244:247], v[108:111], v[16:19], v[244:247]
  ds_read_b128 v[16:19], v10 offset:768
  s_waitcnt lgkmcnt(4)
  v_mfma_f32_16x16x32_bf16 v[240:243], v[112:115], v[224:227], v[240:243]
  v_mfma_f32_16x16x32_bf16 v[244:247], v[116:119], v[224:227], v[244:247]
  ds_read_b128 v[224:227], v11 offset:768
  s_waitcnt lgkmcnt(4)
  v_mfma_f32_16x16x32_bf16 v[240:243], v[120:123], v[228:231], v[240:243]
  v_mfma_f32_16x16x32_bf16 v[244:247], v[124:127], v[228:231], v[244:247]
  s_waitcnt lgkmcnt(3)
  v_mfma_f32_16x16x32_bf16 v[240:243], v[128:131], v[232:235], v[240:243]
  v_mfma_f32_16x16x32_bf16 v[244:247], v[132:135], v[232:235], v[244:247]
  s_waitcnt lgkmcnt(2)
  v_mfma_f32_16x16x32_bf16 v[240:243], v[136:139], v[236:239], v[240:243]
  v_mfma_f32_16x16x32_bf16 v[244:247], v[140:143], v[236:239], v[244:247]
  s_waitcnt lgkmcnt(1)
  v_mfma_f32_16x16x32_bf16 v[240:243], v[144:147], v[16:19], v[240:243]
  v_mfma_f32_16x16x32_bf16 v[244:247], v[148:151], v[16:19], v[244:247]
  s_waitcnt lgkmcnt(0)
  v_mfma_f32_16x16x32_bf16 v[240:243], v[152:155], v[224:227], v[240:243]
  v_mfma_f32_16x16x32_bf16 v[244:247], v[156:159], v[224:227], v[244:247]
  s_nop 6
  v_max3_f32 v224, v240, v241, v242
  v_max3_f32 v225, v244, v245, v246
  v_max3_f32 v224, v224, v243, v247
  v_max_f32 v224, v224, v225
  v_mov_b32 v225, v224
  s_nop 1
  v_permlane16_swap_b32 v224, v225
  v_max_f32 v224, v224, v225
  v_mov_b32 v225, v224
  s_nop 1
  v_permlane32_swap_b32 v224, v225
  v_max_f32 v224, v224, v225
  ds_write_b32 v30, v224 offset:16384
  s_waitcnt lgkmcnt(0)
  s_barrier
  ds_read_b128 v[228:231], v15 offset:16384
  s_waitcnt lgkmcnt(0)
  v_max3_f32 v224, v228, v229, v230
  v_max_f32 v224, v224, v231
  v_sub_f32 v240, v240, v224
  v_sub_f32 v241, v241, v224
  v_sub_f32 v242, v242, v224
  v_sub_f32 v243, v243, v224
  v_sub_f32 v244, v244, v224
  v_sub_f32 v245, v245, v224
  v_sub_f32 v246, v246, v224
  v_sub_f32 v247, v247, v224
  v_exp_f32 v240, v240
  v_exp_f32 v241, v241
  v_exp_f32 v242, v242
  v_exp_f32 v243, v243
  v_exp_f32 v244, v244
  v_exp_f32 v245, v245
  v_exp_f32 v246, v246
  v_exp_f32 v247, v247
  v_cvt_pk_bf16_f32 v228, v240, v241
  v_cvt_pk_bf16_f32 v229, v242, v243
  v_cvt_pk_bf16_f32 v230, v244, v245
  v_cvt_pk_bf16_f32 v231, v246, v247
  ds_write_b128 v252, v[228:231] offset:24576
  s_waitcnt lgkmcnt(0)
  s_barrier
  s_waitcnt lgkmcnt(0)
  ds_read_b128 v[32:35], v6 offset:24576
  ds_read_b128 v[36:39], v6 offset:25600
  ds_read_b128 v[40:43], v6 offset:26624
  ds_read_b128 v[44:47], v6 offset:27648
  ds_read_b128 v[48:51], v6 offset:28672
  ds_read_b128 v[52:55], v6 offset:29696
  ds_read_b128 v[56:59], v6 offset:30720
  ds_read_b128 v[60:63], v6 offset:31744
L_st_19:
  s_cmp_ge_u32 s3, 4
  s_cbranch_scc1 L_pr_20
  s_setprio 2
L_pr_20:
  s_waitcnt lgkmcnt(7)
  v_mfma_f32_32x32x16_bf16 v[96:111], v[32:35], v[160:163], 0
  v_mfma_f32_32x32x16_bf16 v[112:127], v[32:35], v[192:195], 0
  s_waitcnt lgkmcnt(6)
  v_mfma_f32_32x32x16_bf16 v[96:111], v[36:39], v[164:167], v[96:111]
  v_mfma_f32_32x32x16_bf16 v[112:127], v[36:39], v[196:199], v[112:127]
  s_waitcnt lgkmcnt(5)
  v_mfma_f32_32x32x16_bf16 v[96:111], v[40:43], v[168:171], v[96:111]
  v_mfma_f32_32x32x16_bf16 v[112:127], v[40:43], v[200:203], v[112:127]
  s_waitcnt lgkmcnt(4)
  v_mfma_f32_32x32x16_bf16 v[96:111], v[44:47], v[172:175], v[96:111]
  v_mfma_f32_32x32x16_bf16 v[112:127], v[44:47], v[204:207], v[112:127]
  s_waitcnt lgkmcnt(3)
  v_mfma_f32_32x32x16_bf16 v[96:111], v[48:51], v[176:179], v[96:111]
  v_mfma_f32_32x32x16_bf16 v[112:127], v[48:51], v[208:211], v[112:127]
  s_waitcnt lgkmcnt(2)
  v_mfma_f32_32x32x16_bf16 v[96:111], v[52:55], v[180:183], v[96:111]
  v_add_f32 v240, v240, v244
  v_add_f32 v241, v241, v245
  v_add_f32 v242, v242, v246
  v_add_f32 v243, v243, v247
  v_mfma_f32_32x32x16_bf16 v[112:127], v[52:55], v[212:215], v[112:127]
  v_add_f32 v240, v240, v241
  v_add_f32 v242, v242, v243
  s_waitcnt lgkmcnt(1)
  v_mfma_f32_32x32x16_bf16 v[96:111], v[56:59], v[184:187], v[96:111]
  v_add_f32 v240, v240, v242
  v_mfma_f32_32x32x16_bf16 v[112:127], v[56:59], v[216:219], v[112:127]
  v_mov_b32 v241, v240
  s_nop 1
  v_permlane16_swap_b32 v240, v241
  v_add_f32 v240, v240, v241
  s_waitcnt lgkmcnt(0)
  v_mfma_f32_32x32x16_bf16 v[96:111], v[60:63], v[188:191], v[96:111]
  v_mov_b32 v241, v240
  s_nop 1
  v_permlane32_swap_b32 v240, v241
  v_add_f32 v240, v240, v241
  v_mfma_f32_32x32x16_bf16 v[112:127], v[60:63], v[220:223], v[112:127]
  ds_write_b32 v30, v240 offset:17408
  v_lshlrev_b32 v8, 12, v5
  v_lshl_add_u32 v8, v4, 2, v8
  v_add_u32 v9, 8192, v8
  v_add_u32 v10, 16384, v8
  v_add_u32 v11, 24576, v8
  s_mul_i32 s6, s38, 32768
  s_mul_i32 s7, s3, 128
  s_add_u32 s6, s6, s7
  s_add_u32 s6, s6, 1048576
  s_add_u32 s44, s36, s6
  s_addc_u32 s45, s37, 0
  s_mul_i32 s6, s38, 16
  s_add_u32 s6, s6, 491520
  s_add_u32 s58, s36, s6
  s_addc_u32 s59, s37, 0
  v_lshlrev_b32 v16, 11, v1
  v_mov_b32 v17, 0
  v_cvt_pk_bf16_f32 v64, v96, v112
  global_store_dword v8, v64, s[44:45] offset:0 sc1
  v_cvt_pk_bf16_f32 v65, v97, v113
  global_store_dword v8, v65, s[44:45] offset:1024 sc1
  v_cvt_pk_bf16_f32 v66, v98, v114
  global_store_dword v8, v66, s[44:45] offset:2048 sc1
  v_cvt_pk_bf16_f32 v67, v99, v115
  global_store_dword v8, v67, s[44:45] offset:3072 sc1
  v_cvt_pk_bf16_f32 v68, v100, v116
  global_store_dword v9, v68, s[44:45] offset:0 sc1
  v_cvt_pk_bf16_f32 v69, v101, v117
  global_store_dword v9, v69, s[44:45] offset:1024 sc1
  v_cvt_pk_bf16_f32 v70, v102, v118
  global_store_dword v9, v70, s[44:45] offset:2048 sc1
  v_cvt_pk_bf16_f32 v71, v103, v119
  global_store_dword v9, v71, s[44:45] offset:3072 sc1
  v_cvt_pk_bf16_f32 v72, v104, v120
  global_store_dword v10, v72, s[44:45] offset:0 sc1
  v_cvt_pk_bf16_f32 v73, v105, v121
  global_store_dword v10, v73, s[44:45] offset:1024 sc1
  v_cvt_pk_bf16_f32 v74, v106, v122
  global_store_dword v10, v74, s[44:45] offset:2048 sc1
  v_cvt_pk_bf16_f32 v75, v107, v123
  global_store_dword v10, v75, s[44:45] offset:3072 sc1
  v_cvt_pk_bf16_f32 v76, v108, v124
  global_store_dword v11, v76, s[44:45] offset:0 sc1
  v_cvt_pk_bf16_f32 v77, v109, v125
  global_store_dword v11, v77, s[44:45] offset:1024 sc1
  v_cvt_pk_bf16_f32 v78, v110, v126
  global_store_dword v11, v78, s[44:45] offset:2048 sc1
  v_cvt_pk_bf16_f32 v79, v111, v127
  global_store_dword v11, v79, s[44:45] offset:3072 sc1
  s_setprio 0
  v_lshrrev_b32 v9, 2, v2
  v_lshl_add_u32 v9, v3, 2, v9
  v_and_b32 v18, 7, v9
  v_xor_b32 v18, s3, v18
  v_lshlrev_b32 v18, 5, v18
  v_lshl_add_u32 v18, v9, 8, v18
  v_and_b32 v9, 3, v2
  v_lshl_add_u32 v18, v9, 3, v18
  v_add_u32 v18, 32768, v18
  v_lshlrev_b32 v19, 3, v3
  s_lshl_b32 s6, s55, 7
  v_add_u32 v19, s6, v19
  s_mul_i32 s6, s60, 16384
  s_mul_i32 s7, s40, 512
  s_add_u32 s6, s6, s7
  s_add_u32 s6, s6, 196608
  s_add_u32 s56, s36, s6
  s_addc_u32 s57, s37, 0
  v_lshlrev_b32 v9, 15, v3
  v_lshl_add_u32 v9, v2, 4, v9
  v_add_u32 v10, 131072, v9
  v_add_u32 v11, 262144, v9
  v_add_u32 v12, 393216, v9
  s_mul_i32 s6, s3, 524288
  s_mul_i32 s7, s40, 1024
  s_add_u32 s6, s6, s7
  s_mul_i32 s7, s41, 256
  s_add_u32 s6, s6, s7
  s_add_u32 s6, s6, 1048576
  s_add_u32 s44, s36, s6
  s_addc_u32 s45, s37, 0
  v_lshlrev_b32 v13, 4, v2
  v_lshl_add_u32 v13, v3, 2, v13
  s_mul_i32 s6, s3, 272
  s_add_u32 s6, s6, 132096
  v_add_u32 v13, s6, v13
  v_and_b32 v14, 7, v2
  v_mul_u32_u24 v14, 272, v14
  v_lshl_add_u32 v14, v3, 4, v14
  v_add_u32 v14, 132096, v14
  v_lshlrev_b32 v15, 6, v2
  v_lshl_add_u32 v15, v3, 4, v15
  s_mul_i32 s6, s61, 64
  s_mul_i32 s7, s62, 8
  s_add_u32 s6, s6, s7
  s_add_u32 s6, s6, 161792
  v_add_u32 v15, s6, v15
  s_mul_i32 s6, s40, 2048
  s_mul_i32 s7, s41, 512
  s_add_u32 s6, s6, s7
  s_add_u32 s6, s6, 229376
  s_add_u32 s46, s36, s6
  s_addc_u32 s47, s37, 0
  s_mul_i32 s6, s38, 128
  s_add_u32 s6, s6, 442368
  s_add_u32 s98, s36, s6
  s_addc_u32 s99, s37, 0
  v_mov_b32 v251, 0
  s_mul_i32 s6, s38, 256
  s_add_u32 s6, s6, 196608
  s_add_u32 s58, s36, s6
  s_addc_u32 s59, s37, 0
  s_mul_i32 s6, s3, 4096
  s_mul_i32 s7, s40, 8
  s_add_u32 s6, s6, s7
  s_add_u32 s6, s6, 196608
  s_add_u32 s56, s36, s6
  s_addc_u32 s57, s37, 0
  v_add_u32 v16, v2, v3
  v_and_b32 v16, 15, v16
  v_lshlrev_b32 v16, 8, v16
  s_mul_i32 s6, s3, 8
  s_add_u32 s6, s6, 131072
  v_mov_b32 v17, s6
  v_and_b32 v19, 7, v2
  v_lshlrev_b32 v19, 3, v19
  v_add_u32 v19, 131072, v19
  s_waitcnt lgkmcnt(0)
  s_barrier
  s_cmp_lg_u32 s3, 7
  s_cbranch_scc1 L_w7s_21
  v_lshlrev_b32 v8, 4, v4
  ds_read_b128 v[224:227], v8 offset:17408
  ds_read_b128 v[228:231], v8 offset:16384
  s_waitcnt lgkmcnt(0)
  v_add_f32 v224, v224, v225
  v_add_f32 v226, v226, v227
  v_max3_f32 v228, v228, v229, v230
  v_add_f32 v247, v224, v226
  v_max_f32 v246, v228, v231
  s_nop 1
L_w7s_21:
  s_waitcnt vmcnt(0)
  s_waitcnt lgkmcnt(0)
  s_barrier
  s_cmp_lg_u32 s3, 7
  s_cbranch_scc1 L_h3f_22
  s_mov_b32 exec_hi, 0
  global_store_dwordx2 v7, v[246:247], s[58:59] sc1
  s_mov_b64 exec, -1
L_h3f_22:
  ds_read_b64_tr_b16 v[96:97], v18 offset:0
  ds_read_b64_tr_b16 v[98:99], v18 offset:8192
  ds_read_b64_tr_b16 v[100:101], v18 offset:4096
  ds_read_b64_tr_b16 v[102:103], v18 offset:12288
  ds_read_b64_tr_b16 v[104:105], v18 offset:16384
  ds_read_b64_tr_b16 v[106:107], v18 offset:24576
  ds_read_b64_tr_b16 v[108:109], v18 offset:20480
  ds_read_b64_tr_b16 v[110:111], v18 offset:28672
  s_mov_b32 s54, 60000
  s_sleep 16
L_h3f_23:
  global_load_dwordx2 v[56:57], v16, s[56:57] sc1
  s_waitcnt vmcnt(0)
  v_max_u32 v8, v56, v57
  v_cmp_eq_u32 vcc, -1, v8
  s_cbranch_vccz L_h3fd_24
  s_sleep 1
  s_sub_u32 s54, s54, 1
  s_cbranch_scc0 L_h3f_23
L_h3fd_24:
  global_load_dwordx4 v[64:67], v9, s[44:45] sc1
  global_load_dwordx4 v[68:71], v10, s[44:45] sc1
  global_load_dwordx4 v[72:75], v11, s[44:45] sc1
  global_load_dwordx4 v[76:79], v12, s[44:45] sc1
  v_mov_b32 v58, v56
  s_nop 1
  v_max_f32_dpp v58, v58, v58 row_ror:8 row_mask:0xf bank_mask:0xf
  s_nop 1
  v_max_f32_dpp v58, v58, v58 row_ror:4 row_mask:0xf bank_mask:0xf
  s_nop 1
  v_max_f32_dpp v58, v58, v58 row_ror:2 row_mask:0xf bank_mask:0xf
  s_nop 1
  v_max_f32_dpp v58, v58, v58 row_ror:1 row_mask:0xf bank_mask:0xf
  v_sub_f32 v56, v56, v58
  v_exp_f32 v56, v56
  s_nop 0
  v_mul_f32 v59, v56, v57
  v_mov_b32_dpp v48, v56 row_newbcast:0 row_mask:0xf bank_mask:0xf
  v_mov_b32_dpp v49, v56 row_newbcast:4 row_mask:0xf bank_mask:0xf
  v_mov_b32_dpp v50, v56 row_newbcast:8 row_mask:0xf bank_mask:0xf
  v_mov_b32_dpp v51, v56 row_newbcast:12 row_mask:0xf bank_mask:0xf
  v_add_f32_dpp v59, v59, v59 row_ror:8 row_mask:0xf bank_mask:0xf
  s_nop 1
  v_add_f32_dpp v59, v59, v59 row_ror:4 row_mask:0xf bank_mask:0xf
  s_nop 1
  v_add_f32_dpp v59, v59, v59 row_ror:2 row_mask:0xf bank_mask:0xf
  s_nop 1
  v_add_f32_dpp v59, v59, v59 row_ror:1 row_mask:0xf bank_mask:0xf
  ds_write_b64 v17, v[58:59]
  s_waitcnt vmcnt(0)
  s_memrealtime s[100:101]
  v_lshlrev_b32 v88, 16, v64
  v_and_b32 v89, 0xffff0000, v64
  v_lshlrev_b32 v90, 16, v65
  v_and_b32 v91, 0xffff0000, v65
  v_lshlrev_b32 v92, 16, v66
  v_and_b32 v93, 0xffff0000, v66
  v_lshlrev_b32 v94, 16, v67
  v_and_b32 v95, 0xffff0000, v67
  v_pk_mul_f32 v[80:81], v[48:49], v[88:89] op_sel:[0,0] op_sel_hi:[0,1]
  v_pk_mul_f32 v[82:83], v[48:49], v[90:91] op_sel:[0,0] op_sel_hi:[0,1]
  v_pk_mul_f32 v[84:85], v[48:49], v[92:93] op_sel:[0,0] op_sel_hi:[0,1]
  v_pk_mul_f32 v[86:87], v[48:49], v[94:95] op_sel:[0,0] op_sel_hi:[0,1]
  s_cmp_lg_u32 s3, 0
  s_cbranch_scc1 L_hst_25
  s_waitcnt lgkmcnt(0)
  s_and_b32 s100, s100, 0xfffffffe
  v_mov_b32 v250, s100
  s_mov_b64 exec, 1
  global_store_dword v251, v250, s[98:99]
  s_mov_b64 exec, -1
L_hst_25:
  v_lshlrev_b32 v88, 16, v68
  v_and_b32 v89, 0xffff0000, v68
  v_lshlrev_b32 v90, 16, v69
  v_and_b32 v91, 0xffff0000, v69
  v_lshlrev_b32 v92, 16, v70
  v_and_b32 v93, 0xffff0000, v70
  v_lshlrev_b32 v94, 16, v71
  v_and_b32 v95, 0xffff0000, v71
  v_pk_fma_f32 v[80:81], v[48:49], v[88:89], v[80:81] op_sel:[1,0,0] op_sel_hi:[1,1,1]
  v_pk_fma_f32 v[82:83], v[48:49], v[90:91], v[82:83] op_sel:[1,0,0] op_sel_hi:[1,1,1]
  v_pk_fma_f32 v[84:85], v[48:49], v[92:93], v[84:85] op_sel:[1,0,0] op_sel_hi:[1,1,1]
  v_pk_fma_f32 v[86:87], v[48:49], v[94:95], v[86:87] op_sel:[1,0,0] op_sel_hi:[1,1,1]
  v_lshlrev_b32 v88, 16, v72
  v_and_b32 v89, 0xffff0000, v72
  v_lshlrev_b32 v90, 16, v73
  v_and_b32 v91, 0xffff0000, v73
  v_lshlrev_b32 v92, 16, v74
  v_and_b32 v93, 0xffff0000, v74
  v_lshlrev_b32 v94, 16, v75
  v_and_b32 v95, 0xffff0000, v75
  v_pk_fma_f32 v[80:81], v[50:51], v[88:89], v[80:81] op_sel:[0,0,0] op_sel_hi:[0,1,1]
  v_pk_fma_f32 v[82:83], v[50:51], v[90:91], v[82:83] op_sel:[0,0,0] op_sel_hi:[0,1,1]
  v_pk_fma_f32 v[84:85], v[50:51], v[92:93], v[84:85] op_sel:[0,0,0] op_sel_hi:[0,1,1]
  v_pk_fma_f32 v[86:87], v[50:51], v[94:95], v[86:87] op_sel:[0,0,0] op_sel_hi:[0,1,1]
  v_lshlrev_b32 v88, 16, v76
  v_and_b32 v89, 0xffff0000, v76
  v_lshlrev_b32 v90, 16, v77
  v_and_b32 v91, 0xffff0000, v77
  v_lshlrev_b32 v92, 16, v78
  v_and_b32 v93, 0xffff0000, v78
  v_lshlrev_b32 v94, 16, v79
  v_and_b32 v95, 0xffff0000, v79
  v_pk_fma_f32 v[80:81], v[50:51], v[88:89], v[80:81] op_sel:[1,0,0] op_sel_hi:[1,1,1]
  v_pk_fma_f32 v[82:83], v[50:51], v[90:91], v[82:83] op_sel:[1,0,0] op_sel_hi:[1,1,1]
  v_pk_fma_f32 v[84:85], v[50:51], v[92:93], v[84:85] op_sel:[1,0,0] op_sel_hi:[1,1,1]
  v_pk_fma_f32 v[86:87], v[50:51], v[94:95], v[86:87] op_sel:[1,0,0] op_sel_hi:[1,1,1]
  v_permlane32_swap_b32 v80, v81
  v_permlane32_swap_b32 v82, v83
  v_permlane32_swap_b32 v84, v85
  v_permlane32_swap_b32 v86, v87
  v_add_f32 v88, v80, v81
  v_add_f32 v89, v82, v83
  v_add_f32 v90, v84, v85
  v_add_f32 v91, v86, v87
  s_nop 0
  v_permlane16_swap_b32 v88, v90
  v_permlane16_swap_b32 v89, v91
  v_add_f32 v88, v88, v90
  v_add_f32 v89, v89, v91
  v_cvt_pk_bf16_f32 v88, v88, v89
  ds_write_b32 v13, v88
  s_waitcnt lgkmcnt(0)
  s_barrier
  ds_read_b64 v[56:57], v19
  ds_read_b128 v[64:67], v14 offset:0
  ds_read_b128 v[68:71], v14 offset:64
  ds_read_b128 v[72:75], v14 offset:128
  ds_read_b128 v[76:79], v14 offset:192
  s_waitcnt lgkmcnt(3)
  v_mfma_f32_16x16x32_bf16 v[80:83], v[96:99], v[64:67], 0
  v_max_f32_dpp v58, v56, v56 quad_perm:[1,0,3,2] row_mask:0xf bank_mask:0xf
  s_waitcnt lgkmcnt(2)
  v_mfma_f32_16x16x32_bf16 v[80:83], v[100:103], v[68:71], v[80:83]
  v_max_f32_dpp v58, v58, v58 quad_perm:[2,3,0,1] row_mask:0xf bank_mask:0xf
  v_sub_f32 v56, v56, v58
  v_exp_f32 v56, v56
  s_waitcnt lgkmcnt(1)
  v_mfma_f32_16x16x32_bf16 v[80:83], v[104:107], v[72:75], v[80:83]
  v_mul_f32 v57, v56, v57
  s_nop 1
  v_add_f32_dpp v57, v57, v57 quad_perm:[1,0,3,2] row_mask:0xf bank_mask:0xf
  s_waitcnt lgkmcnt(0)
  v_mfma_f32_16x16x32_bf16 v[80:83], v[108:111], v[76:79], v[80:83]
  v_add_f32_dpp v57, v57, v57 quad_perm:[2,3,0,1] row_mask:0xf bank_mask:0xf
  v_rcp_f32 v57, v57
  s_nop 0
  v_mul_f32 v56, v56, v57
  s_nop 3
  v_mul_f32 v80, v80, v56
  v_mul_f32 v81, v81, v56
  v_mul_f32 v82, v82, v56
  v_mul_f32 v83, v83, v56
  v_add_f32_dpp v80, v80, v80 quad_perm:[1,0,3,2] row_mask:0xf bank_mask:0xf
  v_add_f32_dpp v81, v81, v81 quad_perm:[1,0,3,2] row_mask:0xf bank_mask:0xf
  v_add_f32_dpp v82, v82, v82 quad_perm:[1,0,3,2] row_mask:0xf bank_mask:0xf
  v_add_f32_dpp v83, v83, v83 quad_perm:[1,0,3,2] row_mask:0xf bank_mask:0xf
  v_add_f32_dpp v80, v80, v80 quad_perm:[2,3,0,1] row_mask:0xf bank_mask:0xf
  v_add_f32_dpp v81, v81, v81 quad_perm:[2,3,0,1] row_mask:0xf bank_mask:0xf
  v_add_f32_dpp v82, v82, v82 quad_perm:[2,3,0,1] row_mask:0xf bank_mask:0xf
  v_add_f32_dpp v83, v83, v83 quad_perm:[2,3,0,1] row_mask:0xf bank_mask:0xf
  v_cvt_pk_bf16_f32 v80, v80, v81
  v_cvt_pk_bf16_f32 v81, v82, v83
  s_mov_b64 exec, s[50:51]
  ds_write_b64 v15, v[80:81]
  s_mov_b64 exec, -1
  s_waitcnt lgkmcnt(0)
  s_barrier
  s_cmp_lg_u32 s3, 0
  s_cbranch_scc1 L_pub_26
  s_mov_b32 exec_hi, 0
  ds_read_b128 v[64:67], v253
  s_waitcnt lgkmcnt(0)
  global_store_dwordx4 v6, v[64:67], s[46:47]
  s_mov_b64 exec, -1
L_pub_26:
  s_cmp_lg_u32 s3, 0
  s_cbranch_scc1 L_h4a_27
  s_sleep 40
  s_mov_b32 exec_hi, 0
  global_store_dwordx4 v6, v[64:67], s[46:47] sc1
  s_mov_b64 exec, 1
  global_store_dword v251, v250, s[98:99] sc1
  s_mov_b64 exec, -1
L_h4a_27:
  s_branch L_FIN
L_CONT_3:
L_wqd_28:
  s_mul_i32 s6, s41, 1048576
  s_mul_i32 s7, s3, 131072
  s_add_u32 s6, s6, s7
  s_mul_i32 s7, s40, 256
  s_add_u32 s6, s6, s7
  s_add_u32 s44, s14, s6
  s_addc_u32 s45, s15, 0
  v_lshlrev_b32 v24, 12, v5
  v_lshl_add_u32 v24, v4, 4, v24
  v_add_u32 v25, 8192, v24
  v_add_u32 v128, 16384, v24
  v_add_u32 v129, 24576, v24
  s_mul_i32 s6, s41, 512
  s_add_u32 s58, s36, s6
  s_addc_u32 s59, s37, 0
  v_lshrrev_b32 v26, 3, v4
  v_lshlrev_b32 v26, 6, v26
  v_and_b32 v12, 3, v4
  v_lshl_add_u32 v26, v12, 4, v26
  v_bfe_u32 v12, v4, 2, 1
  v_lshl_add_u32 v26, v12, 3, v26
  v_mul_u32_u24 v12, 320, v5
  v_add_u32 v26, v26, v12
  v_add_u32 v26, 131072, v26
  v_and_b32 v12, 1, v2
  v_mul_u32_u24 v27, 320, v12
  v_lshl_add_u32 v27, v3, 4, v27
  v_add_u32 v27, 131072, v27
  v_lshlrev_b32 v30, 8, v2
  v_lshl_add_u32 v30, v3, 3, v30
  s_mul_i32 s6, s3, 32
  s_add_u32 s6, s6, 161792
  v_add_u32 v30, s6, v30
  v_lshlrev_b32 v40, 15, v3
  v_lshl_add_u32 v40, v2, 4, v40
  v_mul_u32_u24 v28, 272, v3
  v_lshl_add_u32 v28, v2, 4, v28
  v_add_u32 v28, 133120, v28
  v_and_b32 v12, 7, v2
  v_mul_u32_u24 v29, 272, v12
  v_lshl_add_u32 v29, v3, 4, v29
  v_add_u32 v29, 133120, v29
  s_mov_b32 s56, 0x3e0293ee
  v_mov_b32 v31, 0
  s_mul_i32 s6, s40, 2048
  s_mul_i32 s7, s41, 512
  s_add_u32 s6, s6, s7
  s_add_u32 s6, s6, 65536
  s_add_u32 s46, s36, s6
  s_addc_u32 s47, s37, 0
  v_lshrrev_b32 v9, 2, v2
  v_lshl_add_u32 v9, v3, 2, v9
  v_and_b32 v41, 7, v9
  v_xor_b32 v41, s3, v41
  v_lshlrev_b32 v41, 5, v41
  v_lshl_add_u32 v41, v9, 8, v41
  v_and_b32 v9, 3, v2
  v_lshl_add_u32 v41, v9, 3, v41
  s_waitcnt vmcnt(0)
  s_mov_b32 s6, 8192
  v_mul_lo_u32 v9, v3, s6
  v_mov_b32 v11, v3
  v_xor_b32 v11, v11, v2
  v_lshl_add_u32 v11, v11, 4, v9
  s_mul_i32 s53, s3, 4096
  s_add_u32 s53, s53, 32768
  s_add_u32 m0, s53, 0
  s_nop 0
  global_load_lds_dwordx4 v11, s[44:45] nt
  v_xor_b32 v12, 64, v11
  v_add_u32 v12, 32768, v12
  s_add_u32 m0, s53, 1024
  s_nop 0
  global_load_lds_dwordx4 v12, s[44:45] nt
  v_xor_b32 v12, 128, v11
  v_add_u32 v12, 65536, v12
  s_add_u32 m0, s53, 2048
  s_nop 0
  global_load_lds_dwordx4 v12, s[44:45] nt
  v_xor_b32 v12, 192, v11
  v_add_u32 v12, 98304, v12
  s_add_u32 m0, s53, 3072
  s_nop 0
  global_load_lds_dwordx4 v12, s[44:45] nt
  s_waitcnt lgkmcnt(0)
  s_barrier
  ds_read_b64_tr_b16 v[96:97], v41 offset:0
  ds_read_b64_tr_b16 v[98:99], v41 offset:4096
  ds_read_b64_tr_b16 v[100:101], v41 offset:8192
  ds_read_b64_tr_b16 v[102:103], v41 offset:12288
  ds_read_b64_tr_b16 v[104:105], v41 offset:16384
  ds_read_b64_tr_b16 v[106:107], v41 offset:20480
  ds_read_b64_tr_b16 v[108:109], v41 offset:24576
  ds_read_b64_tr_b16 v[110:111], v41 offset:28672
  s_cmp_lg_u32 s3, 0
  s_cbranch_scc1 L_ln_30
  v_mov_b32 v20, 0x3f803f80
  v_mov_b32 v14, 0
  v_dot2_f32_bf16 v14, v64, v20, v14
  v_dot2_f32_bf16 v14, v65, v20, v14
  v_dot2_f32_bf16 v14, v66, v20, v14
  v_dot2_f32_bf16 v14, v67, v20, v14
  v_dot2_f32_bf16 v14, v68, v20, v14
  v_dot2_f32_bf16 v14, v69, v20, v14
  v_dot2_f32_bf16 v14, v70, v20, v14
  v_dot2_f32_bf16 v14, v71, v20, v14
  s_nop 2
  v_add_f32_dpp v14, v14, v14 row_ror:8 row_mask:0xf bank_mask:0xf
  s_nop 1
  v_add_f32_dpp v14, v14, v14 row_ror:4 row_mask:0xf bank_mask:0xf
  s_nop 1
  v_add_f32_dpp v14, v14, v14 row_ror:2 row_mask:0xf bank_mask:0xf
  s_nop 1
  v_add_f32_dpp v14, v14, v14 row_ror:1 row_mask:0xf bank_mask:0xf
  v_mov_b32 v21, v14
  s_nop 1
  v_permlane16_swap_b32 v14, v21
  v_add_f32 v14, v14, v21
  v_mul_f32 v14, 0x3b000000, v14
  v_mov_b32 v15, 0
  v_lshlrev_b32 v21, 16, v64
  v_sub_f32 v21, v21, v14
  v_fmac_f32 v15, v21, v21
  v_and_b32 v21, 0xffff0000, v64
  v_sub_f32 v21, v21, v14
  v_fmac_f32 v15, v21, v21
  v_lshlrev_b32 v21, 16, v65
  v_sub_f32 v21, v21, v14
  v_fmac_f32 v15, v21, v21
  v_and_b32 v21, 0xffff0000, v65
  v_sub_f32 v21, v21, v14
  v_fmac_f32 v15, v21, v21
  v_lshlrev_b32 v21, 16, v66
  v_sub_f32 v21, v21, v14
  v_fmac_f32 v15, v21, v21
  v_and_b32 v21, 0xffff0000, v66
  v_sub_f32 v21, v21, v14
  v_fmac_f32 v15, v21, v21
  v_lshlrev_b32 v21, 16, v67
  v_sub_f32 v21, v21, v14
  v_fmac_f32 v15, v21, v21
  v_and_b32 v21, 0xffff0000, v67
  v_sub_f32 v21, v21, v14
  v_fmac_f32 v15, v21, v21
  v_lshlrev_b32 v21, 16, v68
  v_sub_f32 v21, v21, v14
  v_fmac_f32 v15, v21, v21
  v_and_b32 v21, 0xffff0000, v68
  v_sub_f32 v21, v21, v14
  v_fmac_f32 v15, v21, v21
  v_lshlrev_b32 v21, 16, v69
  v_sub_f32 v21, v21, v14
  v_fmac_f32 v15, v21, v21
  v_and_b32 v21, 0xffff0000, v69
  v_sub_f32 v21, v21, v14
  v_fmac_f32 v15, v21, v21
  v_lshlrev_b32 v21, 16, v70
  v_sub_f32 v21, v21, v14
  v_fmac_f32 v15, v21, v21
  v_and_b32 v21, 0xffff0000, v70
  v_sub_f32 v21, v21, v14
  v_fmac_f32 v15, v21, v21
  v_lshlrev_b32 v21, 16, v71
  v_sub_f32 v21, v21, v14
  v_fmac_f32 v15, v21, v21
  v_and_b32 v21, 0xffff0000, v71
  v_sub_f32 v21, v21, v14
  v_fmac_f32 v15, v21, v21
  s_nop 1
  v_add_f32_dpp v15, v15, v15 row_ror:8 row_mask:0xf bank_mask:0xf
  s_nop 1
  v_add_f32_dpp v15, v15, v15 row_ror:4 row_mask:0xf bank_mask:0xf
  s_nop 1
  v_add_f32_dpp v15, v15, v15 row_ror:2 row_mask:0xf bank_mask:0xf
  s_nop 1
  v_add_f32_dpp v15, v15, v15 row_ror:1 row_mask:0xf bank_mask:0xf
  v_mov_b32 v21, v15
  s_nop 1
  v_permlane16_swap_b32 v15, v21
  v_add_f32 v15, v15, v21
  v_mov_b32 v21, 0x3727c5ac
  v_fmac_f32 v21, 0x3b000000, v15
  v_rsq_f32 v15, v21
  v_lshlrev_b32 v20, 16, v18
  v_and_b32 v21, 0xffff0000, v18
  v_lshlrev_b32 v22, 16, v19
  v_and_b32 v23, 0xffff0000, v19
  v_sub_f32 v20, v20, v14
  v_sub_f32 v21, v21, v14
  v_sub_f32 v22, v22, v14
  v_sub_f32 v23, v23, v14
  v_mul_f32 v20, v20, v15
  v_mul_f32 v21, v21, v15
  v_mul_f32 v22, v22, v15
  v_mul_f32 v23, v23, v15
  s_nop 1
L_ln_30:
  s_mov_b32 s54, 60000
  s_mov_b32 s57, s100
  s_cmp_eq_u32 s3, 0
  s_cselect_b32 s7, 0, 8
  s_add_u32 s7, s7, 262
L_h1w_35:
  s_memrealtime s[100:101]
  s_waitcnt lgkmcnt(0)
  s_sub_u32 s6, s100, s57
  s_cmp_lt_u32 s6, s7
  s_cbranch_scc1 L_h1w_35
  s_cmp_lg_u32 s3, 0
  s_cbranch_scc1 L_h10_36
  global_load_dwordx2 v[42:43], v31, s[34:35] sc1
  global_load_dwordx4 v[72:75], v24, s[58:59] sc1
  global_load_dwordx4 v[76:79], v24, s[58:59] offset:2048 sc1
  global_load_dwordx4 v[80:83], v25, s[58:59] sc1
  global_load_dwordx4 v[84:87], v25, s[58:59] offset:2048 sc1
  global_load_dwordx4 v[112:115], v128, s[58:59] sc1
  global_load_dwordx4 v[116:119], v128, s[58:59] offset:2048 sc1
  global_load_dwordx4 v[120:123], v129, s[58:59] sc1
  global_load_dwordx4 v[124:127], v129, s[58:59] offset:2048 sc1
L_h10_36:
  s_cmp_lg_u32 s3, 1
  s_cbranch_scc1 L_fb_31
  v_mov_b32 v8, 128
  global_load_dword v16, v8, s[34:35] sc1
  s_nop 0
L_fb_31:
  s_cmp_lg_u32 s3, 1
  s_cbranch_scc1 L_fb2_38
  s_mov_b32 s54, 60000
  s_mov_b32 s63, 0x01010101
  s_waitcnt vmcnt(0)
L_fl_39:
  v_cmp_ne_u32 vcc, s63, v16
  s_cbranch_vccz L_fld_40
  s_sleep 6
  v_mov_b32 v8, 128
  global_load_dword v16, v8, s[34:35] sc1
  s_waitcnt vmcnt(0)
  s_sub_u32 s54, s54, 1
  s_cbranch_scc0 L_fl_39
L_fld_40:
L_fb2_38:
  s_cmp_lg_u32 s3, 0
  s_cbranch_scc1 L_h1s_32
  s_waitcnt vmcnt(0)
  s_branch L_h1c_37
L_h1l_33:
  global_load_dwordx2 v[42:43], v31, s[34:35] sc1
  global_load_dwordx4 v[72:75], v24, s[58:59] sc1
  global_load_dwordx4 v[76:79], v24, s[58:59] offset:2048 sc1
  global_load_dwordx4 v[80:83], v25, s[58:59] sc1
  global_load_dwordx4 v[84:87], v25, s[58:59] offset:2048 sc1
  global_load_dwordx4 v[112:115], v128, s[58:59] sc1
  global_load_dwordx4 v[116:119], v128, s[58:59] offset:2048 sc1
  global_load_dwordx4 v[120:123], v129, s[58:59] sc1
  global_load_dwordx4 v[124:127], v129, s[58:59] offset:2048 sc1
  s_waitcnt vmcnt(0)
L_h1c_37:
  v_not_b32 v8, v42
  v_and_b32 v8, 1, v8
  v_xor_b32 v9, v74, v42
  v_xor_b32 v10, v75, v43
  v_or3_b32 v8, v8, v9, v10
  v_xor_b32 v9, v78, v42
  v_xor_b32 v10, v79, v43
  v_or3_b32 v8, v8, v9, v10
  v_xor_b32 v9, v82, v42
  v_xor_b32 v10, v83, v43
  v_or3_b32 v8, v8, v9, v10
  v_xor_b32 v9, v86, v42
  v_xor_b32 v10, v87, v43
  v_or3_b32 v8, v8, v9, v10
  v_xor_b32 v9, v114, v42
  v_xor_b32 v10, v115, v43
  v_or3_b32 v8, v8, v9, v10
  v_xor_b32 v9, v118, v42
  v_xor_b32 v10, v119, v43
  v_or3_b32 v8, v8, v9, v10
  v_xor_b32 v9, v122, v42
  v_xor_b32 v10, v123, v43
  v_or3_b32 v8, v8, v9, v10
  v_xor_b32 v9, v126, v42
  v_xor_b32 v10, v127, v43
  v_or3_b32 v8, v8, v9, v10
  v_cmp_ne_u32 vcc, 0, v8
  s_cbranch_vccz L_h1ok_34
  s_sleep 1
  s_sub_u32 s54, s54, 1
  s_cbranch_scc0 L_h1l_33
L_h1ok_34:
  v_mov_b32 v8, 0x00003f80
  v_mov_b32 v9, 0x3f800000
  v_dot2_f32_bf16 v88, v72, v8, v20
  v_dot2_f32_bf16 v92, v76, v8, 0
  v_dot2_f32_bf16 v89, v72, v9, v21
  v_dot2_f32_bf16 v93, v76, v9, 0
  v_dot2_f32_bf16 v90, v73, v8, v22
  v_dot2_f32_bf16 v94, v77, v8, 0
  v_dot2_f32_bf16 v91, v73, v9, v23
  v_dot2_f32_bf16 v95, v77, v9, 0
  v_dot2_f32_bf16 v88, v80, v8, v88
  v_dot2_f32_bf16 v92, v84, v8, v92
  v_dot2_f32_bf16 v89, v80, v9, v89
  v_dot2_f32_bf16 v93, v84, v9, v93
  v_dot2_f32_bf16 v90, v81, v8, v90
  v_dot2_f32_bf16 v94, v85, v8, v94
  v_dot2_f32_bf16 v91, v81, v9, v91
  v_dot2_f32_bf16 v95, v85, v9, v95
  v_dot2_f32_bf16 v88, v112, v8, v88
  v_dot2_f32_bf16 v92, v116, v8, v92
  v_dot2_f32_bf16 v89, v112, v9, v89
  v_dot2_f32_bf16 v93, v116, v9, v93
  v_dot2_f32_bf16 v90, v113, v8, v90
  v_dot2_f32_bf16 v94, v117, v8, v94
  v_dot2_f32_bf16 v91, v113, v9, v91
  v_dot2_f32_bf16 v95, v117, v9, v95
  v_dot2_f32_bf16 v88, v120, v8, v88
  v_dot2_f32_bf16 v92, v124, v8, v92
  v_dot2_f32_bf16 v89, v120, v9, v89
  v_dot2_f32_bf16 v93, v124, v9, v93
  v_dot2_f32_bf16 v90, v121, v8, v90
  v_dot2_f32_bf16 v94, v125, v8, v94
  v_dot2_f32_bf16 v91, v121, v9, v91
  v_dot2_f32_bf16 v95, v125, v9, v95
  v_fmac_f32 v88, v20, v92
  v_fmac_f32 v89, v21, v93
  v_fmac_f32 v90, v22, v94
  v_fmac_f32 v91, v23, v95
  v_cvt_pk_bf16_f32 v88, v88, v89
  v_cvt_pk_bf16_f32 v89, v90, v91
  ds_write_b64 v26, v[88:89]
  s_nop 0
L_h1s_32:
  s_waitcnt lgkmcnt(0)
  s_barrier
  ds_read_b128 v[64:67], v27 offset:0
  ds_read_b128 v[68:71], v27 offset:64
  ds_read_b128 v[72:75], v27 offset:128
  ds_read_b128 v[76:79], v27 offset:192
  s_mov_b64 s[38:39], 0
  s_cmp_lg_u32 s3, 7
  s_cbranch_scc1 L_ga_41
  s_cmp_eq_u64 s[38:39], 0
  s_cbranch_scc0 L_ga_41
  s_mul_i32 s6, s4, 128
  s_add_u32 s6, s6, 475136
  s_add_u32 s98, s36, s6
  s_addc_u32 s99, s37, 0
  v_mov_b32 v248, 0
  v_mov_b32 v249, 1
  s_mov_b64 exec, 1
  global_atomic_add v247, v248, v249, s[98:99] sc0 sc1
  s_mov_b64 exec, -1
L_ga_41:
  s_waitcnt lgkmcnt(3)
  v_mfma_f32_16x16x32_bf16 v[80:83], v[96:99], v[64:67], 0
  s_waitcnt lgkmcnt(2)
  v_mfma_f32_16x16x32_bf16 v[80:83], v[100:103], v[68:71], v[80:83]
  s_waitcnt lgkmcnt(1)
  v_mfma_f32_16x16x32_bf16 v[80:83], v[104:107], v[72:75], v[80:83]
  s_waitcnt lgkmcnt(0)
  v_mfma_f32_16x16x32_bf16 v[80:83], v[108:111], v[76:79], v[80:83]
  s_nop 7
  v_cvt_pk_bf16_f32 v80, v80, v81
  v_cvt_pk_bf16_f32 v81, v82, v83
  s_mov_b64 exec, s[48:49]
  ds_write_b64 v30, v[80:81]
  s_mov_b64 exec, -1
  s_waitcnt lgkmcnt(0)
  s_barrier
  s_cmp_lg_u32 s3, 0
  s_cbranch_scc1 L_pub_42
  s_mov_b32 exec_hi, 0
  ds_read_b128 v[132:135], v253
  s_waitcnt lgkmcnt(0)
  global_store_dwordx4 v6, v[132:135], s[46:47]
  s_mov_b64 exec, -1
L_pub_42:
  s_mov_b64 s[52:53], s[46:47]
  s_mul_i32 s6, s40, 2048
  s_add_u32 s6, s6, 65536
  s_add_u32 s44, s36, s6
  s_addc_u32 s45, s37, 0
  s_mul_i32 s6, s40, 1024
  s_mul_i32 s7, s41, 256
  s_add_u32 s6, s6, s7
  s_add_u32 s6, s6, 131072
  s_add_u32 s46, s36, s6
  s_addc_u32 s47, s37, 0
  s_cmp_eq_u32 s3, 0
  s_cbranch_scc1 L_gw7_43
  s_waitcnt vmcnt(0)
  s_cmp_lg_u32 s3, 7
  s_cbranch_scc1 L_gf_44
  v_readfirstlane_b32 s6, v247
  s_memrealtime s[100:101]
  s_cmp_lg_u32 s6, 14
  s_waitcnt lgkmcnt(0)
  s_cbranch_scc1 L_gf_44
  s_mul_i32 s6, s4, 128
  s_add_u32 s6, s6, 425984
  s_add_u32 s98, s36, s6
  s_addc_u32 s99, s37, 0
  s_and_b32 s100, s100, 0xfffffffe
  v_mov_b32 v251, 0
  v_mov_b32 v250, s100
  s_mov_b64 exec, 1
  global_store_dword v251, v250, s[98:99] sc1
  s_mov_b64 exec, -1
L_gf_44:
L_gw7_43:
  v_xor_b32 v12, v3, v2
  v_lshlrev_b32 v12, 4, v12
  v_lshl_add_u32 v12, v2, 8, v12
  s_mul_i32 s6, s3, 4096
  s_add_u32 s6, s6, 32768
  v_add_u32 v12, s6, v12
  v_xor_b32 v13, 0, v12
  ds_read_b128 v[48:51], v13
  v_xor_b32 v13, 64, v12
  ds_read_b128 v[52:55], v13
  v_xor_b32 v13, 128, v12
  ds_read_b128 v[56:59], v13
  v_xor_b32 v13, 192, v12
  ds_read_b128 v[60:63], v13
  s_cmp_lg_u32 s3, 0
  s_cbranch_scc1 L_hq1_45
  s_mov_b32 s54, 60000
  s_sleep 3
L_hq_46:
  global_load_dwordx4 v[64:67], v6, s[44:45] offset:0 sc1
  global_load_dwordx4 v[68:71], v6, s[44:45] offset:1024 sc1
  s_waitcnt vmcnt(0)
  v_max3_u32 v8, v64, v65, v66
  v_max3_u32 v8, v8, v67, v68
  v_max3_u32 v8, v8, v69, v70
  v_max_u32 v8, v8, v71
  v_cmp_eq_u32 vcc, -1, v8
  s_cbranch_vccz L_hqd_47
  s_cmp_lg_u32 s54, 59996
  s_cbranch_scc1 L_hqf_48
  s_mov_b32 exec_hi, 0
  global_store_dwordx4 v6, v[132:135], s[52:53] sc1
  s_mov_b64 exec, -1
L_hqf_48:
  s_sleep 1
  s_sub_u32 s54, s54, 1
  s_cbranch_scc0 L_hq_46
L_hqd_47:
  ds_write_b128 v28, v[64:67]
  ds_write_b128 v28, v[68:71] offset:1088
L_hq1_45:
  s_waitcnt lgkmcnt(0)
  s_barrier
  ds_read_b128 v[64:67], v29 offset:0
  ds_read_b128 v[68:71], v29 offset:64
  ds_read_b128 v[72:75], v29 offset:128
  ds_read_b128 v[76:79], v29 offset:192
  s_waitcnt lgkmcnt(3)
  v_mfma_f32_16x16x32_bf16 v[80:83], v[48:51], v[64:67], 0
  s_waitcnt lgkmcnt(2)
  v_mfma_f32_16x16x32_bf16 v[80:83], v[52:55], v[68:71], v[80:83]
  s_waitcnt lgkmcnt(1)
  v_mfma_f32_16x16x32_bf16 v[80:83], v[56:59], v[72:75], v[80:83]
  s_waitcnt lgkmcnt(0)
  v_mfma_f32_16x16x32_bf16 v[80:83], v[60:63], v[76:79], v[80:83]
  s_nop 7
  v_add_f32_dpp v80, v80, v80 row_ror:2 row_mask:0xf bank_mask:0xf
  v_add_f32_dpp v81, v81, v81 row_ror:2 row_mask:0xf bank_mask:0xf
  v_add_f32_dpp v82, v82, v82 row_ror:2 row_mask:0xf bank_mask:0xf
  v_add_f32_dpp v83, v83, v83 row_ror:2 row_mask:0xf bank_mask:0xf
  v_add_f32_dpp v80, v80, v80 row_ror:4 row_mask:0xf bank_mask:0xf
  v_add_f32_dpp v81, v81, v81 row_ror:4 row_mask:0xf bank_mask:0xf
  v_add_f32_dpp v82, v82, v82 row_ror:4 row_mask:0xf bank_mask:0xf
  v_add_f32_dpp v83, v83, v83 row_ror:4 row_mask:0xf bank_mask:0xf
  v_mul_f32 v80, s56, v80
  v_mul_f32 v81, s56, v81
  v_mul_f32 v82, s56, v82
  v_mul_f32 v83, s56, v83
  v_cvt_pk_bf16_f32 v80, v80, v81
  v_cvt_pk_bf16_f32 v81, v82, v83
  s_mov_b64 exec, s[48:49]
  ds_write_b64 v30, v[80:81]
  s_mov_b64 exec, -1
  s_waitcnt lgkmcnt(0)
  s_barrier
  s_cmp_lg_u32 s3, 0
  s_cbranch_scc1 L_pub_49
  s_mov_b32 exec_hi, 0
  ds_read_b128 v[64:67], v253
  s_waitcnt lgkmcnt(0)
  global_store_dwordx4 v40, v[64:67], s[46:47] sc1
  s_mov_b64 exec, -1
L_pub_49:
  s_cmp_lg_u32 s3, 0
  s_cbranch_scc1 L_hqa_50
  s_sleep 8
  s_mov_b32 exec_hi, 0
  global_store_dwordx4 v6, v[132:135], s[52:53] sc1
  s_mov_b64 exec, -1
L_hqa_50:
  s_waitcnt lgkmcnt(0)
  s_barrier
  s_cmp_lt_u32 s5, 8
  s_cbranch_scc1 L_ROLE_F
  s_lshl_b32 s43, s4, 2
  s_add_u32 s43, s43, s41
  s_cmp_lt_u32 s5, 12
  s_cbranch_scc1 L_LOAD_H
  s_cmp_ge_u32 s43, 28
  s_cbranch_scc1 L_FIN
  s_cmp_eq_u32 s41, 3
  s_cbranch_scc1 L_g3_51
  s_sleep 30
L_g3_51:
  s_mul_i32 s6, s43, 65536
  s_mul_i32 s7, s3, 128
  s_add_u32 s6, s6, s7
  s_add_u32 s44, s26, s6
  s_addc_u32 s45, s27, 0
  v_lshlrev_b32 v12, 1, v3
  v_and_b32 v9, 7, v1
  v_xor_b32 v12, v12, v9
  v_lshlrev_b32 v12, 4, v12
  v_lshrrev_b32 v9, 3, v1
  v_lshl_add_u32 v12, v9, 10, v12
  global_load_dwordx4 v[160:163], v12, s[44:45] nt
  v_add_u32 v12, 8192, v12
  global_load_dwordx4 v[164:167], v12, s[44:45] nt
  v_add_u32 v12, 8192, v12
  global_load_dwordx4 v[168:171], v12, s[44:45] nt
  v_add_u32 v12, 8192, v12
  global_load_dwordx4 v[172:175], v12, s[44:45] nt
  v_add_u32 v12, 8192, v12
  global_load_dwordx4 v[176:179], v12, s[44:45] nt
  v_add_u32 v12, 8192, v12
  global_load_dwordx4 v[180:183], v12, s[44:45] nt
  v_add_u32 v12, 8192, v12
  global_load_dwordx4 v[184:187], v12, s[44:45] nt
  v_add_u32 v12, 8192, v12
  global_load_dwordx4 v[188:191], v12, s[44:45] nt
  s_mul_i32 s6, s3, 229376
  s_mul_i32 s7, s43, 128
  s_add_u32 s6, s6, s7
  s_add_u32 s44, s22, s6
  s_addc_u32 s45, s23, 0
  v_lshlrev_b32 v11, 1, v3
  v_and_b32 v9, 7, v1
  v_xor_b32 v11, v11, v9
  v_lshlrev_b32 v11, 4, v11
  v_lshrrev_b32 v9, 3, v1
  s_mov_b32 s6, 3584
  v_mul_lo_u32 v9, v9, s6
  v_add_u32 v11, v11, v9
  s_mul_i32 s53, s3, 8192
  s_add_u32 m0, s53, 0
  s_nop 0
  global_load_lds_dwordx4 v11, s[44:45] nt
  v_add_u32 v11, 28672, v11
  s_add_u32 m0, s53, 1024
  s_nop 0
  global_load_lds_dwordx4 v11, s[44:45] nt
  v_add_u32 v11, 28672, v11
  s_add_u32 m0, s53, 2048
  s_nop 0
  global_load_lds_dwordx4 v11, s[44:45] nt
  v_add_u32 v11, 28672, v11
  s_add_u32 m0, s53, 3072
  s_nop 0
  global_load_lds_dwordx4 v11, s[44:45] nt
  v_add_u32 v11, 28672, v11
  s_add_u32 m0, s53, 4096
  s_nop 0
  global_load_lds_dwordx4 v11, s[44:45] nt
  v_add_u32 v11, 28672, v11
  s_add_u32 m0, s53, 5120
  s_nop 0
  global_load_lds_dwordx4 v11, s[44:45] nt
  v_add_u32 v11, 28672, v11
  s_add_u32 m0, s53, 6144
  s_nop 0
  global_load_lds_dwordx4 v11, s[44:45] nt
  v_add_u32 v11, 28672, v11
  s_add_u32 m0, s53, 7168
  s_nop 0
  global_load_lds_dwordx4 v11, s[44:45] nt
  s_mul_i32 s6, s3, 229376
  s_mul_i32 s7, s43, 128
  s_add_u32 s6, s6, s7
  s_add_u32 s44, s24, s6
  s_addc_u32 s45, s25, 0
  v_lshlrev_b32 v11, 1, v3
  v_and_b32 v9, 7, v1
  v_xor_b32 v11, v11, v9
  v_lshlrev_b32 v11, 4, v11
  v_lshrrev_b32 v9, 3, v1
  s_mov_b32 s6, 3584
  v_mul_lo_u32 v9, v9, s6
  v_add_u32 v11, v11, v9
  s_mul_i32 s53, s3, 8192
  s_add_u32 s53, s53, 65536
  s_add_u32 m0, s53, 0
  s_nop 0
  global_load_lds_dwordx4 v11, s[44:45] nt
  v_add_u32 v11, 28672, v11
  s_add_u32 m0, s53, 1024
  s_nop 0
  global_load_lds_dwordx4 v11, s[44:45] nt
  v_add_u32 v11, 28672, v11
  s_add_u32 m0, s53, 2048
  s_nop 0
  global_load_lds_dwordx4 v11, s[44:45] nt
  v_add_u32 v11, 28672, v11
  s_add_u32 m0, s53, 3072
  s_nop 0
  global_load_lds_dwordx4 v11, s[44:45] nt
  v_add_u32 v11, 28672, v11
  s_add_u32 m0, s53, 4096
  s_nop 0
  global_load_lds_dwordx4 v11, s[44:45] nt
  v_add_u32 v11, 28672, v11
  s_add_u32 m0, s53, 5120
  s_nop 0
  global_load_lds_dwordx4 v11, s[44:45] nt
  v_add_u32 v11, 28672, v11
  s_add_u32 m0, s53, 6144
  s_nop 0
  global_load_lds_dwordx4 v11, s[44:45] nt
  v_add_u32 v11, 28672, v11
  s_add_u32 m0, s53, 7168
  s_nop 0
  global_load_lds_dwordx4 v11, s[44:45] nt
  s_waitcnt vmcnt(16)
  s_mul_i32 s6, s3, 4096
  s_add_u32 s6, s6, 131072
  v_add_u32 v13, s6, v6
  v_lshrrev_b32 v9, 2, v2
  v_lshl_add_u32 v9, v3, 2, v9
  v_bfe_u32 v12, v9, 1, 2
  v_lshlrev_b32 v12, 5, v12
  v_lshl_add_u32 v12, v9, 7, v12
  v_and_b32 v9, 3, v2
  v_lshl_add_u32 v12, v9, 3, v12
  s_mul_i32 s6, s3, 4096
  s_add_u32 s6, s6, 131072
  v_add_u32 v12, s6, v12
  ds_write_b128 v13, v[160:163] offset:0
  ds_write_b128 v13, v[164:167] offset:1024
  ds_write_b128 v13, v[168:171] offset:2048
  ds_write_b128 v13, v[172:175] offset:3072
  v_xor_b32 v8, 0, v12
  ds_read_b64_tr_b16 v[32:33], v8
  ds_read_b64_tr_b16 v[34:35], v8 offset:2048
  v_xor_b32 v9, 32, v12
  ds_read_b64_tr_b16 v[40:41], v9
  ds_read_b64_tr_b16 v[42:43], v9 offset:2048
  v_xor_b32 v8, 64, v12
  ds_read_b64_tr_b16 v[48:49], v8
  ds_read_b64_tr_b16 v[50:51], v8 offset:2048
  v_xor_b32 v9, 96, v12
  ds_read_b64_tr_b16 v[56:57], v9
  ds_read_b64_tr_b16 v[58:59], v9 offset:2048
  ds_write_b128 v13, v[176:179] offset:0
  ds_write_b128 v13, v[180:183] offset:1024
  ds_write_b128 v13, v[184:187] offset:2048
  ds_write_b128 v13, v[188:191] offset:3072
  v_xor_b32 v8, 0, v12
  ds_read_b64_tr_b16 v[36:37], v8
  ds_read_b64_tr_b16 v[38:39], v8 offset:2048
  v_xor_b32 v9, 32, v12
  ds_read_b64_tr_b16 v[44:45], v9
  ds_read_b64_tr_b16 v[46:47], v9 offset:2048
  v_xor_b32 v8, 64, v12
  ds_read_b64_tr_b16 v[52:53], v8
  ds_read_b64_tr_b16 v[54:55], v8 offset:2048
  v_xor_b32 v9, 96, v12
  ds_read_b64_tr_b16 v[60:61], v9
  ds_read_b64_tr_b16 v[62:63], v9 offset:2048
  v_bfe_u32 v13, v2, 2, 1
  v_lshlrev_b32 v13, 6, v13
  v_and_b32 v24, 1, v2
  v_lshl_add_u32 v13, v24, 5, v13
  v_lshrrev_b32 v24, 1, v3
  v_lshl_add_u32 v13, v24, 4, v13
  v_bfe_u32 v24, v2, 1, 1
  v_lshl_add_u32 v13, v24, 3, v13
  v_and_b32 v24, 1, v3
  v_lshl_add_u32 v13, v24, 2, v13
  v_lshrrev_b32 v24, 3, v2
  v_mul_u32_u24 v25, 144, v24
  v_add_u32 v13, v13, v25
  s_mul_i32 s6, s3, 4096
  s_add_u32 s6, s6, 131072
  v_add_u32 v13, s6, v13
  v_and_b32 v84, 3, v2
  v_mul_u32_u24 v84, 144, v84
  v_lshl_add_u32 v84, v3, 4, v84
  v_add_u32 v84, s6, v84
  v_and_b32 v85, 1, v2
  v_mul_u32_u24 v85, 144, v85
  v_lshl_add_u32 v85, v3, 4, v85
  v_add_u32 v85, s6, v85
  v_and_b32 v90, 1, v2
  v_lshlrev_b32 v90, 8, v90
  v_lshrrev_b32 v93, 1, v2
  v_lshl_add_u32 v90, v93, 6, v90
  v_lshl_add_u32 v90, v3, 4, v90
  s_add_u32 s6, s6, 1024
  v_add_u32 v90, s6, v90
  v_add_u32 v91, s6, v6
  s_lshl_b32 s6, s3, 13
  v_lshlrev_b32 v24, 3, v24
  v_add_u32 v24, s6, v24
  v_and_b32 v93, 1, v3
  v_and_b32 v25, 7, v2
  v_lshlrev_b32 v25, 13, v25
  v_lshl_add_u32 v25, v93, 3, v25
  v_lshlrev_b32 v92, 6, v2
  v_lshl_add_u32 v92, v3, 4, v92
  v_add_u32 v92, s6, v92
  v_and_b32 v94, 1, v2
  v_lshlrev_b32 v94, 6, v94
  v_bfe_u32 v95, v2, 1, 1
  v_lshl_add_u32 v94, v95, 10, v94
  v_lshrrev_b32 v95, 2, v2
  v_lshl_add_u32 v94, v95, 7, v94
  v_lshl_add_u32 v94, v3, 4, v94
  v_add_u32 v94, s6, v94
  v_lshrrev_b32 v95, 3, v2
  v_lshlrev_b32 v95, 9, v95
  v_lshl_add_u32 v95, v93, 6, v95
  v_and_b32 v93, 7, v2
  v_lshl_add_u32 v95, v93, 2, v95
  s_mul_i32 s6, s61, 128
  s_mul_i32 s7, s62, 32
  s_add_u32 s6, s6, s7
  v_add_u32 v95, s6, v95
  v_add_u32 v93, 1024, v95
  v_lshlrev_b32 v86, 11, v3
  v_lshrrev_b32 v10, 3, v2
  v_lshl_add_u32 v86, v10, 10, v86
  v_and_b32 v10, 7, v2
  v_lshl_add_u32 v86, v10, 4, v86
  v_add_u32 v87, 8192, v86
  s_mul_i32 s6, s3, 128
  s_add_u32 s6, s6, 294912
  s_add_u32 s44, s36, s6
  s_addc_u32 s45, s37, 0
  s_mul_i32 s6, s43, 4096
  s_mul_i32 s7, s3, 256
  s_add_u32 s6, s6, s7
  s_add_u32 s6, s6, 507904
  s_add_u32 s46, s36, s6
  s_addc_u32 s47, s37, 0
  v_lshrrev_b32 v9, 2, v2
  v_lshl_add_u32 v9, v3, 2, v9
  v_bfe_u32 v12, v9, 1, 2
  v_lshlrev_b32 v12, 5, v12
  v_lshl_add_u32 v12, v9, 7, v12
  v_and_b32 v9, 3, v2
  v_lshl_add_u32 v12, v9, 3, v12
  s_mul_i32 s6, s3, 8192
  v_add_u32 v12, s6, v12
  s_mov_b32 s58, 0x000f000f
  s_mov_b32 s59, 0x000f000f
  s_waitcnt vmcnt(8)
  v_and_b32 v244, 7, v2
  v_lshlrev_b32 v244, 5, v244
  v_lshl_add_u32 v244, v3, 3, v244
  v_lshrrev_b32 v245, 1, v244
  v_lshrrev_b32 v246, 3, v2
  v_lshl_add_u32 v245, v246, 10, v245
  v_mul_u32_u24 v246, 12288, v246
  v_add_u32 v244, v244, v246
  s_mul_i32 s6, s3, 128
  s_add_u32 s56, s8, s6
  s_addc_u32 s57, s9, 0
  global_load_dword v16, v245, s[56:57]
  s_mul_i32 s6, s3, 256
  s_add_u32 s6, s6, 364544
  s_add_u32 s56, s36, s6
  s_addc_u32 s57, s37, 0
  v_add_u32 v245, 4096, v244
  v_add_u32 v246, 24576, v244
  v_add_u32 v247, 28672, v244
  global_load_dwordx2 v[18:19], v244, s[56:57] sc1
  global_load_dwordx2 v[20:21], v244, s[56:57] offset:2048 sc1
  global_load_dwordx2 v[22:23], v245, s[56:57] sc1
  global_load_dwordx2 v[26:27], v246, s[56:57] sc1
  global_load_dwordx2 v[28:29], v246, s[56:57] offset:2048 sc1
  global_load_dwordx2 v[30:31], v247, s[56:57] sc1
  v_xor_b32 v8, 0, v12
  ds_read_b64_tr_b16 v[96:97], v8 offset:0
  ds_read_b64_tr_b16 v[98:99], v8 offset:2048
  ds_read_b64_tr_b16 v[100:101], v8 offset:4096
  ds_read_b64_tr_b16 v[102:103], v8 offset:6144
  v_xor_b32 v9, 32, v12
  ds_read_b64_tr_b16 v[104:105], v9 offset:0
  ds_read_b64_tr_b16 v[106:107], v9 offset:2048
  ds_read_b64_tr_b16 v[108:109], v9 offset:4096
  ds_read_b64_tr_b16 v[110:111], v9 offset:6144
  v_xor_b32 v8, 64, v12
  ds_read_b64_tr_b16 v[112:113], v8 offset:0
  ds_read_b64_tr_b16 v[114:115], v8 offset:2048
  ds_read_b64_tr_b16 v[116:117], v8 offset:4096
  ds_read_b64_tr_b16 v[118:119], v8 offset:6144
  v_xor_b32 v9, 96, v12
  ds_read_b64_tr_b16 v[120:121], v9 offset:0
  ds_read_b64_tr_b16 v[122:123], v9 offset:2048
  ds_read_b64_tr_b16 v[124:125], v9 offset:4096
  ds_read_b64_tr_b16 v[126:127], v9 offset:6144
  v_add_u32 v12, 65536, v12
  s_waitcnt vmcnt(7)
  v_xor_b32 v8, 0, v12
  ds_read_b64_tr_b16 v[128:129], v8 offset:0
  ds_read_b64_tr_b16 v[130:131], v8 offset:2048
  ds_read_b64_tr_b16 v[132:133], v8 offset:4096
  ds_read_b64_tr_b16 v[134:135], v8 offset:6144
  v_xor_b32 v9, 32, v12
  ds_read_b64_tr_b16 v[136:137], v9 offset:0
  ds_read_b64_tr_b16 v[138:139], v9 offset:2048
  ds_read_b64_tr_b16 v[140:141], v9 offset:4096
  ds_read_b64_tr_b16 v[142:143], v9 offset:6144
  v_xor_b32 v8, 64, v12
  ds_read_b64_tr_b16 v[144:145], v8 offset:0
  ds_read_b64_tr_b16 v[146:147], v8 offset:2048
  ds_read_b64_tr_b16 v[148:149], v8 offset:4096
  ds_read_b64_tr_b16 v[150:151], v8 offset:6144
  v_xor_b32 v9, 96, v12
  ds_read_b64_tr_b16 v[152:153], v9 offset:0
  ds_read_b64_tr_b16 v[154:155], v9 offset:2048
  ds_read_b64_tr_b16 v[156:157], v9 offset:4096
  ds_read_b64_tr_b16 v[158:159], v9 offset:6144
  s_waitcnt vmcnt(0)
  v_max3_u32 v10, v18, v19, v20
  v_max3_u32 v10, v10, v21, v22
  v_max3_u32 v10, v10, v23, v26
  v_max3_u32 v10, v10, v27, v28
  v_max3_u32 v10, v10, v29, v30
  v_max_u32 v10, v10, v31
  v_cmp_eq_u32 vcc, -1, v10
  s_cbranch_vccz L_mrok_52
  s_mov_b32 s54, 60000
  s_nop 2
L_mr_53:
  global_load_dwordx2 v[18:19], v244, s[56:57] sc1
  global_load_dwordx2 v[20:21], v244, s[56:57] offset:2048 sc1
  global_load_dwordx2 v[22:23], v245, s[56:57] sc1
  global_load_dwordx2 v[26:27], v246, s[56:57] sc1
  global_load_dwordx2 v[28:29], v246, s[56:57] offset:2048 sc1
  global_load_dwordx2 v[30:31], v247, s[56:57] sc1
  s_waitcnt vmcnt(0)
  v_max3_u32 v10, v18, v19, v20
  v_max3_u32 v10, v10, v21, v22
  v_max3_u32 v10, v10, v23, v26
  v_max3_u32 v10, v10, v27, v28
  v_max3_u32 v10, v10, v29, v30
  v_max_u32 v10, v10, v31
  v_cmp_eq_u32 vcc, -1, v10
  s_cbranch_vccz L_mrd_54
  s_sleep 2
  s_sub_u32 s54, s54, 1
  s_cbranch_scc0 L_mr_53
L_mrd_54:
L_mrok_52:
  v_add_f32 v18, v18, v26
  v_add_f32 v19, v19, v27
  v_add_f32 v20, v20, v28
  v_add_f32 v21, v21, v29
  v_add_f32 v22, v22, v30
  v_add_f32 v23, v23, v31
  v_add_f32 v22, 1.0, v22
  v_add_f32 v23, 1.0, v23
  v_and_b32 v17, 0xffff0000, v16
  v_lshlrev_b32 v16, 16, v16
  v_cvt_pk_bf16_f32 v64, v22, v23
  v_cvt_pk_bf16_f32 v65, v20, v21
  ds_write_b32 v13, v64
  ds_write_b32 v13, v65 offset:288
  ds_read_b128 v[64:67], v84
  ds_read_b128 v[68:71], v84 offset:64
  v_and_b32 v28, 1, v3
  v_mul_u32_u24 v28, 192, v28
  v_lshrrev_b32 v29, 2, v2
  v_lshl_add_u32 v28, v29, 4, v28
  v_and_b32 v29, 3, v2
  v_lshl_add_u32 v28, v29, 1, v28
  s_bfe_u32 s57, s3, 0x10001
  s_mul_i32 s6, s60, 64
  s_mul_i32 s7, s62, 32
  s_add_u32 s6, s6, s7
  s_mul_i32 s7, s57, 8
  s_add_u32 s6, s6, s7
  s_add_u32 s6, s6, 4096
  v_add_u32 v28, s6, v28
  v_and_b32 v29, 1, v2
  v_mul_u32_u24 v29, 192, v29
  v_lshl_add_u32 v29, v3, 4, v29
  v_add_u32 v29, 4096, v29
  v_lshlrev_b32 v26, 11, v3
  v_lshl_add_u32 v26, v2, 4, v26
  v_mov_b32 v30, 0x00003f80
  v_mov_b32 v31, 0x3f800000
  s_mov_b32 s56, 0xbdd2d3e8
  v_mov_b32 v20, 0xc0135761
  v_mov_b32 v21, 0x3727c5ac
  s_waitcnt lgkmcnt(0)
  v_mfma_f32_16x16x32_bf16 v[160:163], v[96:99], v[64:67], 0
  v_mfma_f32_16x16x32_bf16 v[164:167], v[104:107], v[64:67], 0
  v_mfma_f32_16x16x32_bf16 v[168:171], v[112:115], v[64:67], 0
  v_mfma_f32_16x16x32_bf16 v[172:175], v[120:123], v[64:67], 0
  v_mfma_f32_16x16x32_bf16 v[160:163], v[100:103], v[68:71], v[160:163]
  v_mfma_f32_16x16x32_bf16 v[164:167], v[108:111], v[68:71], v[164:167]
  v_mfma_f32_16x16x32_bf16 v[168:171], v[116:119], v[68:71], v[168:171]
  v_mfma_f32_16x16x32_bf16 v[172:175], v[124:127], v[68:71], v[172:175]
  s_lshl_b64 exec, s[58:59], 4
  s_nop 4
  v_mov_b64 v[160:161], v[164:165]
  v_mov_b64 v[162:163], v[166:167]
  s_lshl_b64 exec, s[58:59], 8
  v_mov_b64 v[160:161], v[168:169]
  v_mov_b64 v[162:163], v[170:171]
  s_lshl_b64 exec, s[58:59], 12
  v_mov_b64 v[160:161], v[172:173]
  v_mov_b64 v[162:163], v[174:175]
  s_mov_b64 exec, -1
  ds_write_b128 v94, v[160:163] offset:0
  s_waitcnt lgkmcnt(0)
  v_mfma_f32_16x16x32_bf16 v[160:163], v[128:131], v[64:67], 0
  v_mfma_f32_16x16x32_bf16 v[164:167], v[136:139], v[64:67], 0
  v_mfma_f32_16x16x32_bf16 v[168:171], v[144:147], v[64:67], 0
  v_mfma_f32_16x16x32_bf16 v[172:175], v[152:155], v[64:67], 0
  v_mfma_f32_16x16x32_bf16 v[160:163], v[132:135], v[68:71], v[160:163]
  v_mfma_f32_16x16x32_bf16 v[164:167], v[140:143], v[68:71], v[164:167]
  v_mfma_f32_16x16x32_bf16 v[168:171], v[148:151], v[68:71], v[168:171]
  v_mfma_f32_16x16x32_bf16 v[172:175], v[156:159], v[68:71], v[172:175]
  s_lshl_b64 exec, s[58:59], 4
  s_nop 4
  v_mov_b64 v[160:161], v[164:165]
  v_mov_b64 v[162:163], v[166:167]
  s_lshl_b64 exec, s[58:59], 8
  v_mov_b64 v[160:161], v[168:169]
  v_mov_b64 v[162:163], v[170:171]
  s_lshl_b64 exec, s[58:59], 12
  v_mov_b64 v[160:161], v[172:173]
  v_mov_b64 v[162:163], v[174:175]
  s_mov_b64 exec, -1
  ds_write_b128 v94, v[160:163] offset:512
  s_cmp_lg_u32 s3, 0
  s_cbranch_scc1 L_hms_55
  s_mul_i32 s6, s41, 128
  s_add_u32 s6, s6, 458752
  s_add_u32 s98, s36, s6
  s_addc_u32 s99, s37, 0
  v_and_b32 v15, 7, v1
  v_lshlrev_b32 v15, 10, v15
  s_mov_b32 s54, 60000
  s_nop 0
L_hm_57:
  global_load_dword v14, v15, s[98:99] sc1
  s_waitcnt vmcnt(0)
  v_cmp_eq_u32 vcc, -1, v14
  s_cbranch_vccz L_hmd_58
  s_sleep 1
  s_sub_u32 s54, s54, 1
  s_cbranch_scc0 L_hm_57
L_hmd_58:
  v_mov_b32 v8, 40
  s_nop 1
L_hmw_56:
  s_memrealtime s[100:101]
  s_waitcnt lgkmcnt(0)
  v_sub_u32 v15, s100, v14
  v_cmp_lt_u32 vcc, v15, v8
  s_cbranch_vccnz L_hmw_56
  s_nop 3
L_hms_55:
  s_waitcnt lgkmcnt(0)
  s_barrier
  global_load_dwordx4 v[64:67], v86, s[44:45] sc1
  global_load_dwordx4 v[68:71], v87, s[44:45] sc1
  ds_read2st64_b32 v[72:73], v95 offset0:0 offset1:32
  ds_read2st64_b32 v[74:75], v95 offset0:64 offset1:96
  ds_read2st64_b32 v[76:77], v95 offset0:128 offset1:160
  ds_read2st64_b32 v[78:79], v95 offset0:192 offset1:224
  ds_read2st64_b32 v[160:161], v93 offset0:0 offset1:32
  ds_read2st64_b32 v[162:163], v93 offset0:64 offset1:96
  ds_read2st64_b32 v[164:165], v93 offset0:128 offset1:160
  ds_read2st64_b32 v[166:167], v93 offset0:192 offset1:224
  s_waitcnt lgkmcnt(0)
  v_add_f32 v72, v72, v76
  v_add_f32 v73, v73, v77
  v_add_f32 v74, v74, v78
  v_add_f32 v75, v75, v79
  v_add_f32 v72, v72, v74
  v_add_f32 v73, v73, v75
  v_add_f32 v88, v72, v73
  v_add_f32 v160, v160, v164
  v_add_f32 v161, v161, v165
  v_add_f32 v162, v162, v166
  v_add_f32 v163, v163, v167
  v_add_f32 v160, v160, v162
  v_add_f32 v161, v161, v163
  v_add_f32 v89, v160, v161
  v_add_u32 v95, 3072, v95
  v_add_u32 v92, 3072, v92
  s_waitcnt vmcnt(0)
  v_max3_u32 v8, v64, v65, v66
  v_max3_u32 v8, v8, v67, v68
  v_max3_u32 v8, v8, v69, v70
  v_max_u32 v8, v8, v71
  v_cmp_eq_u32 vcc, -1, v8
  s_cbranch_vccz L_h5k_59
  s_mov_b32 s54, 60000
  s_nop 2
L_h5_60:
  global_load_dwordx4 v[64:67], v86, s[44:45] sc1
  global_load_dwordx4 v[68:71], v87, s[44:45] sc1
  s_waitcnt vmcnt(0)
  v_max3_u32 v8, v64, v65, v66
  v_max3_u32 v8, v8, v67, v68
  v_max3_u32 v8, v8, v69, v70
  v_max_u32 v8, v8, v71
  v_cmp_eq_u32 vcc, -1, v8
  s_cbranch_vccz L_h5d_61
  s_sleep 1
  s_sub_u32 s54, s54, 1
  s_cbranch_scc0 L_h5_60
L_h5d_61:
L_h5k_59:
  v_dot2_f32_bf16 v72, v64, v30, 0
  v_dot2_f32_bf16 v73, v64, v31, 0
  v_dot2_f32_bf16 v74, v65, v30, 0
  v_dot2_f32_bf16 v75, v65, v31, 0
  v_dot2_f32_bf16 v76, v66, v30, 0
  v_dot2_f32_bf16 v77, v66, v31, 0
  v_dot2_f32_bf16 v78, v67, v30, 0
  v_dot2_f32_bf16 v79, v67, v31, 0
  v_dot2_f32_bf16 v72, v68, v30, v72
  v_dot2_f32_bf16 v73, v68, v31, v73
  v_dot2_f32_bf16 v74, v69, v30, v74
  v_dot2_f32_bf16 v75, v69, v31, v75
  v_dot2_f32_bf16 v76, v70, v30, v76
  v_dot2_f32_bf16 v77, v70, v31, v77
  v_dot2_f32_bf16 v78, v71, v30, v78
  v_dot2_f32_bf16 v79, v71, v31, v79
  v_permlane32_swap_b32 v72, v76
  v_permlane32_swap_b32 v73, v77
  v_permlane32_swap_b32 v74, v78
  v_permlane32_swap_b32 v75, v79
  v_add_f32 v72, v72, v76
  v_add_f32 v73, v73, v77
  v_add_f32 v74, v74, v78
  v_add_f32 v75, v75, v79
  s_nop 0
  v_permlane16_swap_b32 v72, v74
  v_permlane16_swap_b32 v73, v75
  v_add_f32 v72, v72, v74
  v_add_f32 v73, v73, v75
  v_fma_f32 v76, v18, v72, v16
  v_fma_f32 v77, v19, v73, v17
  v_mul_f32 v78, v76, v22
  v_mul_f32 v79, v77, v23
  v_cvt_pk_bf16_f32 v78, v78, v79
  ds_write_b32 v13, v78
  ds_read_b128 v[64:67], v85
  ds_read_b128 v[68:71], v85 offset:64
  s_waitcnt lgkmcnt(1)
  v_mfma_f32_16x16x32_bf16 v[160:163], v[96:99], v[64:67], 0
  v_add_f32 v80, v76, v77
  v_mul_f32 v81, v76, v76
  v_mfma_f32_16x16x32_bf16 v[164:167], v[104:107], v[64:67], 0
  v_fmac_f32 v81, v77, v77
  v_mfma_f32_16x16x32_bf16 v[168:171], v[112:115], v[64:67], 0
  v_add_f32_dpp v80, v80, v80 quad_perm:[1,0,3,2] row_mask:0xf bank_mask:0xf
  v_add_f32_dpp v81, v81, v81 quad_perm:[1,0,3,2] row_mask:0xf bank_mask:0xf
  v_mfma_f32_16x16x32_bf16 v[172:175], v[120:123], v[64:67], 0
  v_add_f32_dpp v80, v80, v80 quad_perm:[2,3,0,1] row_mask:0xf bank_mask:0xf
  v_add_f32_dpp v81, v81, v81 quad_perm:[2,3,0,1] row_mask:0xf bank_mask:0xf
  v_mfma_f32_16x16x32_bf16 v[176:179], v[128:131], v[64:67], 0
  v_add_f32_dpp v80, v80, v80 row_half_mirror row_mask:0xf bank_mask:0xf
  v_add_f32_dpp v81, v81, v81 row_half_mirror row_mask:0xf bank_mask:0xf
  v_mfma_f32_16x16x32_bf16 v[180:183], v[136:139], v[64:67], 0
  v_mov_b32 v82, v80
  v_mov_b32 v83, v81
  v_mfma_f32_16x16x32_bf16 v[184:187], v[144:147], v[64:67], 0
  v_permlane16_swap_b32 v80, v82
  v_permlane16_swap_b32 v81, v83
  v_mfma_f32_16x16x32_bf16 v[188:191], v[152:155], v[64:67], 0
  v_add_f32 v80, v80, v82
  v_add_f32 v81, v81, v83
  s_waitcnt lgkmcnt(0)
  v_mfma_f32_16x16x32_bf16 v[160:163], v[100:103], v[68:71], v[160:163]
  v_mov_b32 v82, v80
  v_mov_b32 v83, v81
  v_mfma_f32_16x16x32_bf16 v[164:167], v[108:111], v[68:71], v[164:167]
  v_permlane32_swap_b32 v80, v82
  v_permlane32_swap_b32 v81, v83
  v_mfma_f32_16x16x32_bf16 v[168:171], v[116:119], v[68:71], v[168:171]
  v_add_f32 v80, v80, v82
  v_add_f32 v81, v81, v83
  v_mfma_f32_16x16x32_bf16 v[172:175], v[124:127], v[68:71], v[172:175]
  s_mov_b64 exec, 0x101
  ds_write_b64 v24, v[80:81] offset:2048
  s_mov_b64 exec, -1
  v_mfma_f32_16x16x32_bf16 v[176:179], v[132:135], v[68:71], v[176:179]
  v_mfma_f32_16x16x32_bf16 v[180:183], v[140:143], v[68:71], v[180:183]
  s_lshl_b64 exec, s[48:49], 2
  v_mov_b64 v[160:161], v[164:165]
  v_mov_b64 v[162:163], v[166:167]
  v_mfma_f32_16x16x32_bf16 v[184:187], v[148:151], v[68:71], v[184:187]
  s_lshl_b64 exec, s[48:49], 4
  v_mov_b64 v[160:161], v[168:169]
  v_mov_b64 v[162:163], v[170:171]
  v_mfma_f32_16x16x32_bf16 v[188:191], v[156:159], v[68:71], v[188:191]
  s_lshl_b64 exec, s[48:49], 6
  v_mov_b64 v[160:161], v[172:173]
  v_mov_b64 v[162:163], v[174:175]
  s_lshl_b64 exec, s[48:49], 8
  v_mov_b64 v[160:161], v[176:177]
  v_mov_b64 v[162:163], v[178:179]
  s_lshl_b64 exec, s[48:49], 10
  v_mov_b64 v[160:161], v[180:181]
  v_mov_b64 v[162:163], v[182:183]
  s_lshl_b64 exec, s[48:49], 12
  v_mov_b64 v[160:161], v[184:185]
  v_mov_b64 v[162:163], v[186:187]
  s_lshl_b64 exec, s[48:49], 14
  v_mov_b64 v[160:161], v[188:189]
  v_mov_b64 v[162:163], v[190:191]
  s_mov_b64 exec, -1
  ds_write_b128 v92, v[160:163]
  s_mov_b32 exec_hi, 0
  s_waitcnt lgkmcnt(0)
  s_barrier
  ds_read_b64 v[80:81], v25 offset:2048
  ds_read2st64_b32 v[72:73], v95 offset0:0 offset1:32
  ds_read2st64_b32 v[74:75], v95 offset0:64 offset1:96
  ds_read2st64_b32 v[76:77], v95 offset0:128 offset1:160
  ds_read2st64_b32 v[78:79], v95 offset0:192 offset1:224
  s_waitcnt lgkmcnt(4)
  v_add_f32_dpp v80, v80, v80 quad_perm:[1,0,3,2] row_mask:0xf bank_mask:0xf
  v_add_f32_dpp v81, v81, v81 quad_perm:[1,0,3,2] row_mask:0xf bank_mask:0xf
  s_nop 0
  v_add_f32_dpp v80, v80, v80 quad_perm:[2,3,0,1] row_mask:0xf bank_mask:0xf
  v_add_f32_dpp v81, v81, v81 quad_perm:[2,3,0,1] row_mask:0xf bank_mask:0xf
  s_nop 0
  v_add_f32_dpp v80, v80, v80 row_half_mirror row_mask:0xf bank_mask:0xf
  v_add_f32_dpp v81, v81, v81 row_half_mirror row_mask:0xf bank_mask:0xf
  v_mul_f32 v80, 0xbb000000, v80
  v_fmac_f32 v21, 0x3b000000, v81
  v_fma_f32 v21, -v80, v80, v21
  v_rsq_f32 v81, v21
  s_waitcnt lgkmcnt(0)
  v_fmac_f32 v72, v80, v88
  v_add_f32 v72, v72, v76
  v_add_f32 v73, v73, v77
  v_add_f32 v74, v74, v78
  v_add_f32 v75, v75, v79
  v_add_f32 v72, v72, v74
  v_add_f32 v73, v73, v75
  v_add_f32 v72, v72, v73
  v_fma_f32 v72, v81, v72, v89
  v_mul_f32 v73, v72, v72
  v_fma_f32 v73, v73, s56, v20
  v_mul_f32 v73, v73, v72
  v_exp_f32 v73, v73
  v_mul_f32_dpp v74, v72, v72 row_ror:8 row_mask:0xf bank_mask:0xf
  v_add_f32 v73, 1.0, v73
  v_rcp_f32 v73, v73
  s_nop 0
  v_mul_f32 v74, v74, v73
  v_cvt_pk_bf16_f32 v74, v74, v74
  s_mov_b32 exec_lo, 0x00ff00ff
  ds_write_b16 v28, v74
  s_mov_b64 exec, -1
  s_waitcnt lgkmcnt(0)
  s_barrier
  ds_read_b128 v[64:67], v29
  ds_read_b128 v[68:71], v29 offset:64
  s_waitcnt lgkmcnt(0)
  v_mfma_f32_16x16x32_bf16 v[72:75], v[32:35], v[64:67], 0
  v_mfma_f32_16x16x32_bf16 v[76:79], v[40:43], v[64:67], 0
  v_mfma_f32_16x16x32_bf16 v[80:83], v[48:51], v[64:67], 0
  v_mfma_f32_16x16x32_bf16 v[84:87], v[56:59], v[64:67], 0
  v_mfma_f32_16x16x32_bf16 v[72:75], v[36:39], v[68:71], v[72:75]
  v_mfma_f32_16x16x32_bf16 v[76:79], v[44:47], v[68:71], v[76:79]
  v_mfma_f32_16x16x32_bf16 v[80:83], v[52:55], v[68:71], v[80:83]
  v_mfma_f32_16x16x32_bf16 v[84:87], v[60:63], v[68:71], v[84:87]
  s_lshl_b64 exec, s[48:49], 2
  s_nop 4
  v_mov_b64 v[72:73], v[76:77]
  v_mov_b64 v[74:75], v[78:79]
  s_lshl_b64 exec, s[48:49], 4
  v_mov_b64 v[72:73], v[80:81]
  v_mov_b64 v[74:75], v[82:83]
  s_lshl_b64 exec, s[48:49], 6
  v_mov_b64 v[72:73], v[84:85]
  v_mov_b64 v[74:75], v[86:87]
  s_mov_b32 exec_lo, 0x00ff00ff
  s_mov_b32 exec_hi, 0x00ff00ff
  ds_write_b128 v90, v[72:75]
  s_mov_b32 exec_lo, -1
  s_mov_b32 exec_hi, 0
  ds_read_b128 v[64:67], v91
  s_waitcnt lgkmcnt(0)
  global_store_dwordx4 v26, v[64:67], s[46:47] sc1
  s_mov_b64 exec, -1
  s_nop 0
  s_branch L_FIN
L_LOAD_H:
  s_cmp_lg_u32 s3, 0
  s_cbranch_scc1 L_FIN
  v_lshrrev_b32 v9, 3, v1
  v_bfe_u32 v10, v1, 2, 1
  v_and_b32 v11, 3, v1
  v_lshlrev_b32 v12, 12, v9
  v_lshl_add_u32 v12, v10, 11, v12
  v_lshl_add_u32 v12, v11, 4, v12
  v_add_u32 v13, 32768, v12
  v_add_u32 v14, 65536, v12
  v_and_b32 v15, 3, v9
  v_lshlrev_b32 v15, 12, v15
  v_lshl_add_u32 v15, v10, 11, v15
  v_lshl_add_u32 v15, v11, 4, v15
  v_add_u32 v15, 98304, v15
  v_and_b32 v16, 1, v9
  v_lshl_add_u32 v16, v16, 1, v10
  v_mul_u32_u24 v16, 12288, v16
  v_lshl_add_u32 v16, v11, 4, v16
  v_add_u32 v17, 6144, v16
  s_mul_i32 s6, s43, 64
  s_add_u32 s6, s6, 364544
  s_add_u32 s44, s36, s6
  s_addc_u32 s45, s37, 0
  v_lshlrev_b32 v18, 10, v10
  v_lshl_add_u32 v18, v11, 3, v18
  s_mul_i32 s6, s43, 32
  s_add_u32 s46, s8, s6
  s_addc_u32 s47, s9, 0
  global_load_dwordx2 v[20:21], v18, s[46:47]
  s_lshl_b32 s97, s4, 3
  s_add_u32 s97, s97, s5
  s_sub_u32 s97, s97, 8
  s_mul_i32 s6, s41, 128
  s_add_u32 s6, s6, 459264
  s_add_u32 s98, s36, s6
  s_addc_u32 s99, s37, 0
  v_and_b32 v19, 7, v1
  v_lshlrev_b32 v19, 10, v19
  s_mov_b32 s54, 60000
  s_sleep 20
L_hu_62:
  global_load_dword v56, v19, s[98:99] sc1
  s_waitcnt vmcnt(0)
  v_cmp_eq_u32 vcc, -1, v56
  s_cbranch_vccz L_hud_63
  s_sleep 8
  s_sub_u32 s54, s54, 1
  s_cbranch_scc0 L_hu_62
L_hud_63:
  s_mov_b32 s54, 60000
L_mg_64:
  global_load_dwordx4 v[24:27], v16, s[44:45] sc1
  global_load_dwordx4 v[28:31], v17, s[44:45] sc1
  s_waitcnt vmcnt(0)
  v_max3_u32 v8, v24, v25, v26
  v_max3_u32 v8, v8, v27, v28
  v_max3_u32 v8, v8, v29, v30
  v_max_u32 v8, v8, v31
  v_cmp_eq_u32 vcc, -1, v8
  s_cbranch_vccz L_mgd_65
  s_sleep 2
  s_sub_u32 s54, s54, 1
  s_cbranch_scc0 L_mg_64
L_mgd_65:
  v_add_f32_dpp v24, v24, v24 row_ror:8 row_mask:0xf bank_mask:0xf
  v_add_f32_dpp v25, v25, v25 row_ror:8 row_mask:0xf bank_mask:0xf
  v_add_f32_dpp v26, v26, v26 row_ror:8 row_mask:0xf bank_mask:0xf
  v_add_f32_dpp v27, v27, v27 row_ror:8 row_mask:0xf bank_mask:0xf
  v_add_f32_dpp v28, v28, v28 row_ror:8 row_mask:0xf bank_mask:0xf
  v_add_f32_dpp v29, v29, v29 row_ror:8 row_mask:0xf bank_mask:0xf
  v_add_f32_dpp v30, v30, v30 row_ror:8 row_mask:0xf bank_mask:0xf
  v_add_f32_dpp v31, v31, v31 row_ror:8 row_mask:0xf bank_mask:0xf
  v_and_b32 v23, 0xffff0000, v21
  v_lshlrev_b32 v22, 16, v21
  v_and_b32 v21, 0xffff0000, v20
  v_lshlrev_b32 v20, 16, v20
  s_mul_i32 s6, s43, 32
  s_add_u32 s6, s6, 294912
  s_add_u32 s44, s36, s6
  s_addc_u32 s45, s37, 0
  v_lshrrev_b32 v59, 1, v12
  s_mul_i32 s6, s43, 32
  s_add_u32 s46, s32, s6
  s_addc_u32 s47, s33, 0
  v_mov_b32 v58, 138
  s_nop 1
L_fw_66:
  s_memrealtime s[100:101]
  s_waitcnt lgkmcnt(0)
  v_sub_u32 v57, s100, v56
  v_cmp_lt_u32 vcc, v57, v58
  s_cbranch_vccnz L_fw_66
  s_mov_b32 s54, 60000
  s_nop 2
L_h5_67:
  global_load_dwordx2 v[34:35], v59, s[44:45] sc1
  s_waitcnt vmcnt(0)
  v_max_u32 v8, v34, v35
  v_cmp_eq_u32 vcc, -1, v8
  s_cbranch_vccz L_h5d_68
  s_sleep 8
  s_sub_u32 s54, s54, 1
  s_cbranch_scc0 L_h5_67
L_h5d_68:
  v_lshlrev_b32 v32, 16, v34
  v_and_b32 v33, 0xffff0000, v34
  v_lshlrev_b32 v34, 16, v35
  v_and_b32 v35, 0xffff0000, v35
  v_add_f32_dpp v32, v32, v32 row_ror:8 row_mask:0xf bank_mask:0xf
  v_add_f32_dpp v33, v33, v33 row_ror:8 row_mask:0xf bank_mask:0xf
  v_add_f32_dpp v34, v34, v34 row_ror:8 row_mask:0xf bank_mask:0xf
  v_add_f32_dpp v35, v35, v35 row_ror:8 row_mask:0xf bank_mask:0xf
  v_mov_b32 v60, v32
  v_mov_b32 v61, v33
  v_mov_b32 v62, v34
  v_mov_b32 v63, v35
  v_permlane16_swap_b32 v32, v60
  v_permlane16_swap_b32 v33, v61
  v_permlane16_swap_b32 v34, v62
  v_permlane16_swap_b32 v35, v63
  v_add_f32 v32, v32, v60
  v_add_f32 v33, v33, v61
  v_add_f32 v34, v34, v62
  v_add_f32 v35, v35, v63
  v_mov_b32 v60, v32
  v_mov_b32 v61, v33
  v_mov_b32 v62, v34
  v_mov_b32 v63, v35
  v_permlane32_swap_b32 v32, v60
  v_permlane32_swap_b32 v33, v61
  v_permlane32_swap_b32 v34, v62
  v_permlane32_swap_b32 v35, v63
  v_add_f32 v32, v32, v60
  v_add_f32 v33, v33, v61
  v_add_f32 v34, v34, v62
  v_add_f32 v35, v35, v63
  v_fma_f32 v20, v24, v32, v20
  v_fma_f32 v21, v25, v33, v21
  v_fma_f32 v22, v26, v34, v22
  v_fma_f32 v23, v27, v35, v23
  s_mul_i32 s6, s43, 64
  s_add_u32 s6, s6, 507904
  s_add_u32 s44, s36, s6
  s_addc_u32 s45, s37, 0
  v_cmp_gt_u32 vcc, 32, v1
  s_nop 1
  v_cndmask_b32 v19, 0, 1.0, vcc
  v_mov_b32 v58, 231
  s_nop 1
L_fw_69:
  s_memrealtime s[100:101]
  s_waitcnt lgkmcnt(0)
  v_sub_u32 v57, s100, v56
  v_cmp_lt_u32 vcc, v57, v58
  s_cbranch_vccnz L_fw_69
  s_mov_b32 s54, 60000
  s_nop 2
L_h7_70:
  global_load_dwordx4 v[36:39], v12, s[44:45] sc1
  global_load_dwordx4 v[40:43], v13, s[44:45] sc1
  global_load_dwordx4 v[44:47], v14, s[44:45] sc1
  global_load_dwordx4 v[48:51], v15, s[44:45] sc1
  s_waitcnt vmcnt(0)
  v_max3_u32 v8, v36, v37, v38
  v_max3_u32 v8, v8, v39, v40
  v_max3_u32 v8, v8, v41, v42
  v_max3_u32 v8, v8, v43, v44
  v_max3_u32 v8, v8, v45, v46
  v_max3_u32 v8, v8, v47, v48
  v_max3_u32 v8, v8, v49, v50
  v_max_u32 v8, v8, v51
  v_cmp_eq_u32 vcc, -1, v8
  s_cbranch_vccz L_h7d_71
  s_sleep 4
  s_sub_u32 s54, s54, 1
  s_cbranch_scc0 L_h7_70
L_h7d_71:
  v_add_f32 v36, v36, v40
  v_add_f32 v37, v37, v41
  v_add_f32 v38, v38, v42
  v_add_f32 v39, v39, v43
  v_fma_f32 v44, v48, v19, v44
  v_fma_f32 v45, v49, v19, v45
  v_fma_f32 v46, v50, v19, v46
  v_fma_f32 v47, v51, v19, v47
  v_add_f32 v36, v36, v44
  v_add_f32 v37, v37, v45
  v_add_f32 v38, v38, v46
  v_add_f32 v39, v39, v47
  v_add_f32_dpp v36, v36, v36 row_ror:8 row_mask:0xf bank_mask:0xf
  v_add_f32_dpp v37, v37, v37 row_ror:8 row_mask:0xf bank_mask:0xf
  v_add_f32_dpp v38, v38, v38 row_ror:8 row_mask:0xf bank_mask:0xf
  v_add_f32_dpp v39, v39, v39 row_ror:8 row_mask:0xf bank_mask:0xf
  v_mov_b32 v60, v36
  v_mov_b32 v61, v37
  v_mov_b32 v62, v38
  v_mov_b32 v63, v39
  v_permlane16_swap_b32 v36, v60
  v_permlane16_swap_b32 v37, v61
  v_permlane16_swap_b32 v38, v62
  v_permlane16_swap_b32 v39, v63
  v_add_f32 v36, v36, v60
  v_add_f32 v37, v37, v61
  v_add_f32 v38, v38, v62
  v_add_f32 v39, v39, v63
  v_mov_b32 v60, v36
  v_mov_b32 v61, v37
  v_mov_b32 v62, v38
  v_mov_b32 v63, v39
  v_permlane32_swap_b32 v36, v60
  v_permlane32_swap_b32 v37, v61
  v_permlane32_swap_b32 v38, v62
  v_permlane32_swap_b32 v39, v63
  v_add_f32 v36, v36, v60
  v_add_f32 v37, v37, v61
  v_add_f32 v38, v38, v62
  v_add_f32 v39, v39, v63
  v_fma_f32 v36, v28, v36, v20
  v_fma_f32 v37, v29, v37, v21
  v_fma_f32 v38, v30, v38, v22
  v_fma_f32 v39, v31, v39, v23
  v_cvt_pk_bf16_f32 v36, v36, v37
  v_cvt_pk_bf16_f32 v37, v38, v39
  s_mov_b64 exec, 0xff
  global_store_dwordx2 v18, v[36:37], s[46:47]
  s_mov_b64 exec, -1
  s_branch L_FIN
L_ROLE_F:
  s_cmp_eq_u32 s5, 3
  s_cbranch_scc1 L_f3_72
  s_sleep 25
L_f3_72:
  s_lshl_b32 s6, s4, 3
  s_add_u32 s6, s6, s5
  s_lshr_b32 s56, s6, 5
  s_and_b32 s57, s6, 31
  s_add_u32 s57, s57, 16
  v_and_b32 v8, 1, v3
  v_lshlrev_b32 v8, 10, v8
  v_lshl_add_u32 v8, v2, 2, v8
  s_mul_i32 s6, s56, 512
  s_mul_i32 s7, s3, 64
  s_add_u32 s6, s6, s7
  v_add_u32 v8, s6, v8
  global_load_dword v24, v8, s[28:29]
  s_mul_i32 s6, s56, 1572864
  s_mul_i32 s7, s3, 196608
  s_add_u32 s6, s6, s7
  s_mul_i32 s7, s57, 128
  s_add_u32 s6, s6, s7
  s_add_u32 s44, s30, s6
  s_addc_u32 s45, s31, 0
  v_lshlrev_b32 v11, 1, v3
  v_and_b32 v9, 7, v1
  v_xor_b32 v11, v11, v9
  v_lshlrev_b32 v11, 4, v11
  v_lshrrev_b32 v9, 3, v1
  s_mov_b32 s6, 6144
  v_mul_lo_u32 v9, v9, s6
  v_add_u32 v11, v11, v9
  s_mul_i32 s53, s3, 4096
  s_add_u32 s53, s53, 65536
  s_add_u32 m0, s53, 0
  s_nop 0
  global_load_lds_dwordx4 v11, s[44:45] nt
  v_add_u32 v11, 49152, v11
  s_add_u32 m0, s53, 1024
  s_nop 0
  global_load_lds_dwordx4 v11, s[44:45] nt
  v_add_u32 v11, 49152, v11
  s_add_u32 m0, s53, 2048
  s_nop 0
  global_load_lds_dwordx4 v11, s[44:45] nt
  v_add_u32 v11, 49152, v11
  s_add_u32 m0, s53, 3072
  s_nop 0
  global_load_lds_dwordx4 v11, s[44:45] nt
  s_waitcnt vmcnt(4)
  v_lshlrev_b32 v28, 16, v24
  v_and_b32 v29, 0xffff0000, v24
  s_mov_b32 s6, 0xbfb8aa3b
  v_mul_f32 v30, s6, v28
  v_mul_f32 v31, s6, v29
  v_exp_f32 v30, v30
  v_exp_f32 v31, v31
  v_add_f32 v30, 1.0, v30
  v_add_f32 v31, 1.0, v31
  v_rcp_f32 v30, v30
  v_rcp_f32 v31, v31
  v_mul_f32 v28, v28, v30
  v_mul_f32 v29, v29, v31
  v_cvt_pk_bf16_f32 v28, v28, v29
  s_mul_i32 s6, s3, 256
  s_add_u32 s6, s6, 98304
  v_lshlrev_b32 v8, 2, v1
  v_add_u32 v8, s6, v8
  ds_write_b32 v8, v28
  v_and_b32 v9, 1, v2
  v_lshlrev_b32 v9, 6, v9
  v_lshl_add_u32 v9, v3, 3, v9
  v_add_u32 v9, s6, v9
  s_waitcnt lgkmcnt(0)
  ds_read2_b64 v[48:51], v9 offset0:0 offset1:4
  v_lshrrev_b32 v9, 2, v2
  v_lshl_add_u32 v9, v3, 2, v9
  v_bfe_u32 v12, v9, 1, 2
  v_lshlrev_b32 v12, 5, v12
  v_lshl_add_u32 v12, v9, 7, v12
  v_and_b32 v9, 3, v2
  v_lshl_add_u32 v12, v9, 3, v12
  s_mul_i32 s6, s3, 4096
  s_add_u32 s6, s6, 65536
  v_add_u32 v12, s6, v12
  v_lshlrev_b32 v14, 6, v2
  v_lshl_add_u32 v14, v3, 4, v14
  s_mul_i32 s6, s3, 512
  s_add_u32 s6, s6, 100352
  v_add_u32 v14, s6, v14
  v_lshrrev_b32 v15, 1, v2
  v_lshlrev_b32 v15, 9, v15
  v_and_b32 v10, 1, v2
  v_lshl_add_u32 v15, v10, 6, v15
  v_lshl_add_u32 v15, v3, 4, v15
  s_mul_i32 s6, s55, 128
  s_add_u32 s6, s6, 100352
  v_add_u32 v15, s6, v15
  s_mov_b32 s6, 12288
  v_mul_lo_u32 v26, v2, s6
  v_lshl_add_u32 v26, v3, 4, v26
  s_mul_i32 s6, s56, 24576
  s_mul_i32 s7, s57, 256
  s_add_u32 s6, s6, s7
  s_mul_i32 s7, s55, 64
  s_add_u32 s6, s6, s7
  s_add_u32 s6, s6, 360448
  s_add_u32 s46, s36, s6
  s_addc_u32 s47, s37, 0
  s_waitcnt vmcnt(0)
  v_xor_b32 v13, 0, v12
  ds_read_b64_tr_b16 v[56:57], v13
  ds_read_b64_tr_b16 v[58:59], v13 offset:2048
  v_xor_b32 v13, 32, v12
  ds_read_b64_tr_b16 v[60:61], v13
  ds_read_b64_tr_b16 v[62:63], v13 offset:2048
  v_xor_b32 v13, 64, v12
  ds_read_b64_tr_b16 v[64:65], v13
  ds_read_b64_tr_b16 v[66:67], v13 offset:2048
  v_xor_b32 v13, 96, v12
  ds_read_b64_tr_b16 v[68:69], v13
  ds_read_b64_tr_b16 v[70:71], v13 offset:2048
  s_waitcnt lgkmcnt(6)
  v_mfma_f32_16x16x32_bf16 v[72:75], v[56:59], v[48:51], 0
  s_waitcnt lgkmcnt(4)
  v_mfma_f32_16x16x32_bf16 v[76:79], v[60:63], v[48:51], 0
  s_waitcnt lgkmcnt(2)
  v_mfma_f32_16x16x32_bf16 v[80:83], v[64:67], v[48:51], 0
  s_waitcnt lgkmcnt(0)
  v_mfma_f32_16x16x32_bf16 v[84:87], v[68:71], v[48:51], 0
  s_mov_b64 exec, s[48:49]
  s_nop 0
  ds_write_b128 v14, v[72:75] offset:0
  s_nop 0
  ds_write_b128 v14, v[76:79] offset:128
  s_nop 0
  ds_write_b128 v14, v[80:83] offset:256
  s_nop 0
  ds_write_b128 v14, v[84:87] offset:384
  s_mov_b64 exec, -1
  s_waitcnt lgkmcnt(0)
  s_barrier
  s_cmp_ge_u32 s3, 4
  s_cbranch_scc1 L_mw_73
  ds_read_b128 v[72:75], v15
  s_waitcnt lgkmcnt(0)
  v_add_f32_dpp v72, v72, v72 row_ror:8 row_mask:0xf bank_mask:0xf
  v_add_f32_dpp v73, v73, v73 row_ror:8 row_mask:0xf bank_mask:0xf
  v_add_f32_dpp v74, v74, v74 row_ror:8 row_mask:0xf bank_mask:0xf
  v_add_f32_dpp v75, v75, v75 row_ror:8 row_mask:0xf bank_mask:0xf
  v_add_f32_dpp v72, v72, v72 row_ror:4 row_mask:0xf bank_mask:0xf
  v_add_f32_dpp v73, v73, v73 row_ror:4 row_mask:0xf bank_mask:0xf
  v_add_f32_dpp v74, v74, v74 row_ror:4 row_mask:0xf bank_mask:0xf
  v_add_f32_dpp v75, v75, v75 row_ror:4 row_mask:0xf bank_mask:0xf
  v_add_f32_dpp v72, v72, v72 row_ror:2 row_mask:0xf bank_mask:0xf
  v_add_f32_dpp v73, v73, v73 row_ror:2 row_mask:0xf bank_mask:0xf
  v_add_f32_dpp v74, v74, v74 row_ror:2 row_mask:0xf bank_mask:0xf
  v_add_f32_dpp v75, v75, v75 row_ror:2 row_mask:0xf bank_mask:0xf
  s_mov_b64 exec, s[48:49]
  global_store_dwordx4 v26, v[72:75], s[46:47] sc1
  s_mov_b64 exec, -1
  s_nop 0
L_mw_73:
  s_mul_i32 s6, s4, 524288
  s_mul_i32 s7, s3, 65536
  s_add_u32 s6, s6, s7
  s_mul_i32 s7, s5, 128
  s_add_u32 s6, s6, s7
  s_add_u32 s44, s18, s6
  s_addc_u32 s45, s19, 0
  v_lshlrev_b32 v11, 1, v3
  v_and_b32 v9, 7, v1
  v_xor_b32 v11, v11, v9
  v_lshlrev_b32 v11, 4, v11
  v_lshrrev_b32 v9, 3, v1
  s_mov_b32 s6, 1024
  v_mul_lo_u32 v9, v9, s6
  v_add_u32 v11, v11, v9
  s_mul_i32 s53, s3, 8192
  s_add_u32 m0, s53, 0
  s_nop 0
  global_load_lds_dwordx4 v11, s[44:45] nt
  v_add_u32 v11, 8192, v11
  s_add_u32 m0, s53, 1024
  s_nop 0
  global_load_lds_dwordx4 v11, s[44:45] nt
  v_add_u32 v11, 8192, v11
  s_add_u32 m0, s53, 2048
  s_nop 0
  global_load_lds_dwordx4 v11, s[44:45] nt
  v_add_u32 v11, 8192, v11
  s_add_u32 m0, s53, 3072
  s_nop 0
  global_load_lds_dwordx4 v11, s[44:45] nt
  v_add_u32 v11, 8192, v11
  s_add_u32 m0, s53, 4096
  s_nop 0
  global_load_lds_dwordx4 v11, s[44:45] nt
  v_add_u32 v11, 8192, v11
  s_add_u32 m0, s53, 5120
  s_nop 0
  global_load_lds_dwordx4 v11, s[44:45] nt
  v_add_u32 v11, 8192, v11
  s_add_u32 m0, s53, 6144
  s_nop 0
  global_load_lds_dwordx4 v11, s[44:45] nt
  v_add_u32 v11, 8192, v11
  s_add_u32 m0, s53, 7168
  s_nop 0
  global_load_lds_dwordx4 v11, s[44:45] nt
  v_lshrrev_b32 v9, 2, v2
  v_lshl_add_u32 v9, v3, 2, v9
  v_bfe_u32 v12, v9, 1, 2
  v_lshlrev_b32 v12, 5, v12
  v_lshl_add_u32 v12, v9, 7, v12
  v_and_b32 v9, 3, v2
  v_lshl_add_u32 v12, v9, 3, v12
  s_mul_i32 s6, s3, 8192
  v_add_u32 v12, s6, v12
  s_waitcnt vmcnt(0)
  v_xor_b32 v13, 0, v12
  ds_read_b64_tr_b16 v[96:97], v13 offset:0
  ds_read_b64_tr_b16 v[98:99], v13 offset:2048
  ds_read_b64_tr_b16 v[100:101], v13 offset:4096
  ds_read_b64_tr_b16 v[102:103], v13 offset:6144
  v_xor_b32 v13, 32, v12
  ds_read_b64_tr_b16 v[104:105], v13 offset:0
  ds_read_b64_tr_b16 v[106:107], v13 offset:2048
  ds_read_b64_tr_b16 v[108:109], v13 offset:4096
  ds_read_b64_tr_b16 v[110:111], v13 offset:6144
  v_xor_b32 v13, 64, v12
  ds_read_b64_tr_b16 v[112:113], v13 offset:0
  ds_read_b64_tr_b16 v[114:115], v13 offset:2048
  ds_read_b64_tr_b16 v[116:117], v13 offset:4096
  ds_read_b64_tr_b16 v[118:119], v13 offset:6144
  v_xor_b32 v13, 96, v12
  ds_read_b64_tr_b16 v[120:121], v13 offset:0
  ds_read_b64_tr_b16 v[122:123], v13 offset:2048
  ds_read_b64_tr_b16 v[124:125], v13 offset:4096
  ds_read_b64_tr_b16 v[126:127], v13 offset:6144
  v_lshrrev_b32 v10, 3, v1
  v_xor_b32 v9, v10, v1
  v_and_b32 v9, 7, v9
  v_lshlrev_b32 v9, 4, v9
  v_lshl_add_u32 v9, v10, 8, v9
  v_and_b32 v10, 7, v2
  v_xor_b32 v16, v10, v3
  v_lshlrev_b32 v16, 4, v16
  v_lshl_add_u32 v16, v10, 7, v16
  s_mul_i32 s6, s3, 1024
  s_add_u32 s6, s6, 114688
  s_mov_b32 m0, s6
  v_add_u32 v16, s6, v16
  v_xor_b32 v17, 64, v16
  s_mul_i32 s6, s4, 8192
  s_mul_i32 s7, s61, 2048
  s_add_u32 s6, s6, s7
  s_mul_i32 s7, s62, 128
  s_add_u32 s6, s6, s7
  s_add_u32 s6, s6, 229376
  s_add_u32 s44, s36, s6
  s_addc_u32 s45, s37, 0
  v_and_b32 v10, 1, v2
  v_lshl_add_u32 v10, v3, 1, v10
  v_lshlrev_b32 v10, 9, v10
  v_bfe_u32 v11, v2, 1, 2
  v_lshl_add_u32 v10, v11, 4, v10
  v_lshrrev_b32 v11, 3, v2
  v_lshl_add_u32 v10, v11, 13, v10
  s_mul_i32 s6, s3, 64
  s_add_u32 s6, s6, 131072
  v_add_u32 v10, s6, v10
  v_lshlrev_b32 v11, 9, v3
  v_lshl_add_u32 v11, v2, 4, v11
  s_mul_i32 s6, s3, 2048
  s_add_u32 s6, s6, 131072
  v_add_u32 v11, s6, v11
  v_and_b32 v12, 1, v3
  v_lshlrev_b32 v12, 7, v12
  v_lshrrev_b32 v13, 1, v3
  v_lshl_add_u32 v12, v13, 3, v12
  s_mul_i32 s6, s3, 16
  s_add_u32 s6, s6, 161792
  v_add_u32 v12, s6, v12
  v_lshrrev_b32 v13, 3, v2
  v_lshlrev_b32 v13, 10, v13
  v_and_b32 v14, 7, v2
  v_lshl_add_u32 v13, v14, 4, v13
  s_mul_i32 s6, s4, 2048
  s_mul_i32 s7, s5, 128
  s_add_u32 s6, s6, s7
  s_add_u32 s6, s6, 294912
  s_add_u32 s46, s36, s6
  s_addc_u32 s47, s37, 0
  s_mov_b32 s56, 0x00ff00ff
  s_mov_b32 s57, 0x00ff00ff
  s_mov_b32 s58, 0x00010001
  s_mov_b32 s59, 0x00010001
  s_lshl_b32 s97, s4, 3
  s_add_u32 s97, s97, s5
  s_mul_i32 s6, s97, 128
  s_add_u32 s6, s6, 458752
  s_add_u32 s38, s36, s6
  s_addc_u32 s39, s37, 0
  v_mov_b32 v251, 0
  s_cmp_lg_u32 s3, 0
  s_nop 0
  s_cbranch_scc1 L_hms_74
  s_mul_i32 s6, s4, 128
  s_add_u32 s6, s6, 442368
  s_add_u32 s98, s36, s6
  s_addc_u32 s99, s37, 0
  v_and_b32 v15, 15, v1
  v_lshlrev_b32 v15, 10, v15
  s_mov_b32 s54, 60000
  s_nop 0
L_hm_76:
  global_load_dword v14, v15, s[98:99] sc1
  s_waitcnt vmcnt(0)
  v_cmp_eq_u32 vcc, -1, v14
  s_cbranch_vccz L_hmd_77
  s_sleep 1
  s_sub_u32 s54, s54, 1
  s_cbranch_scc0 L_hm_76
L_hmd_77:
  v_mov_b32 v8, 56
  s_nop 1
L_hmw_75:
  s_memrealtime s[100:101]
  s_waitcnt lgkmcnt(0)
  v_sub_u32 v15, s100, v14
  v_cmp_lt_u32 vcc, v15, v8
  s_cbranch_vccnz L_hmw_75
  s_nop 3
L_hms_74:
  s_waitcnt lgkmcnt(0)
  s_barrier
  s_mov_b32 s54, 60000
L_h4_78:
  global_load_lds_dwordx4 v9, s[44:45] sc1
  s_waitcnt vmcnt(0)
  ds_read_b128 v[64:67], v16
  ds_read_b128 v[68:71], v17
  s_waitcnt lgkmcnt(0)
  v_max3_u32 v8, v64, v65, v66
  v_max3_u32 v8, v8, v67, v68
  v_max3_u32 v8, v8, v69, v70
  v_max_u32 v8, v8, v71
  v_cmp_eq_u32 vcc, -1, v8
  s_cbranch_vccz L_h4d_79
  s_sleep 1
  s_sub_u32 s54, s54, 1
  s_cbranch_scc0 L_h4_78
L_h4d_79:
  s_memrealtime s[100:101]
  v_mfma_f32_16x16x32_bf16 v[72:75], v[96:99], v[64:67], 0
  v_mfma_f32_16x16x32_bf16 v[76:79], v[104:107], v[64:67], 0
  v_mfma_f32_16x16x32_bf16 v[80:83], v[112:115], v[64:67], 0
  v_mfma_f32_16x16x32_bf16 v[84:87], v[120:123], v[64:67], 0
  v_mfma_f32_16x16x32_bf16 v[72:75], v[100:103], v[68:71], v[72:75]
  v_mfma_f32_16x16x32_bf16 v[76:79], v[108:111], v[68:71], v[76:79]
  v_mfma_f32_16x16x32_bf16 v[80:83], v[116:119], v[68:71], v[80:83]
  v_mfma_f32_16x16x32_bf16 v[84:87], v[124:127], v[68:71], v[84:87]
  s_cmp_lg_u32 s3, 0
  s_cbranch_scc1 L_hst_80
  s_waitcnt lgkmcnt(0)
  s_and_b32 s100, s100, 0xfffffffe
  v_mov_b32 v250, s100
  s_mov_b64 exec, 1
  global_store_dword v251, v250, s[38:39] sc1
  s_mov_b64 exec, -1
L_hst_80:
  s_not_b64 exec, s[56:57]
  s_nop 3
  v_mov_b64 v[72:73], v[80:81]
  v_mov_b64 v[74:75], v[82:83]
  v_mov_b64 v[76:77], v[84:85]
  v_mov_b64 v[78:79], v[86:87]
  s_mov_b64 exec, -1
  ds_write_b128 v10, v[72:75] offset:0
  ds_write_b128 v10, v[76:79] offset:4096
  s_waitcnt lgkmcnt(0)
  s_barrier
  ds_read_b128 v[64:67], v11
  ds_read_b128 v[68:71], v11 offset:256
  s_waitcnt lgkmcnt(0)
  v_add_f32 v64, v64, v68
  v_add_f32 v65, v65, v69
  v_add_f32 v66, v66, v70
  v_add_f32 v67, v67, v71
  v_add_f32_dpp v64, v64, v64 row_ror:8 row_mask:0xf bank_mask:0xf
  v_add_f32_dpp v65, v65, v65 row_ror:8 row_mask:0xf bank_mask:0xf
  v_add_f32_dpp v66, v66, v66 row_ror:8 row_mask:0xf bank_mask:0xf
  v_add_f32_dpp v67, v67, v67 row_ror:8 row_mask:0xf bank_mask:0xf
  v_add_f32_dpp v64, v64, v64 row_ror:4 row_mask:0xf bank_mask:0xf
  v_add_f32_dpp v65, v65, v65 row_ror:4 row_mask:0xf bank_mask:0xf
  v_add_f32_dpp v66, v66, v66 row_ror:4 row_mask:0xf bank_mask:0xf
  v_add_f32_dpp v67, v67, v67 row_ror:4 row_mask:0xf bank_mask:0xf
  v_add_f32_dpp v64, v64, v64 row_ror:2 row_mask:0xf bank_mask:0xf
  v_add_f32_dpp v65, v65, v65 row_ror:2 row_mask:0xf bank_mask:0xf
  v_add_f32_dpp v66, v66, v66 row_ror:2 row_mask:0xf bank_mask:0xf
  v_add_f32_dpp v67, v67, v67 row_ror:2 row_mask:0xf bank_mask:0xf
  v_add_f32_dpp v64, v64, v64 row_ror:1 row_mask:0xf bank_mask:0xf
  v_add_f32_dpp v65, v65, v65 row_ror:1 row_mask:0xf bank_mask:0xf
  v_add_f32_dpp v66, v66, v66 row_ror:1 row_mask:0xf bank_mask:0xf
  v_add_f32_dpp v67, v67, v67 row_ror:1 row_mask:0xf bank_mask:0xf
  v_cvt_pk_bf16_f32 v64, v64, v65
  v_cvt_pk_bf16_f32 v65, v66, v67
  s_mov_b64 exec, s[58:59]
  ds_write_b64 v12, v[64:65]
  s_mov_b64 exec, -1
  s_waitcnt lgkmcnt(0)
  s_barrier
  s_cmp_lg_u32 s3, 0
  s_cbranch_scc1 L_pub_81
  s_mov_b64 exec, 0xffff
  ds_read_b128 v[68:71], v253
  s_waitcnt lgkmcnt(0)
  global_store_dwordx4 v13, v[68:71], s[46:47] sc1
  s_mov_b64 exec, -1
L_pub_81:
  s_nop 0
  s_branch L_FIN
L_FIN:
L_END:
  s_endpgm
.section .rodata,"a"
.p2align 6
.amdhsa_kernel adaLN_cond__compressed_kv_cla__glu_gated_geglu__decode_kernel
  .amdhsa_next_free_vgpr 256
  .amdhsa_next_free_sgpr 102
  .amdhsa_accum_offset 256
  .amdhsa_group_segment_fixed_size 0
  .amdhsa_kernarg_size 120
  .amdhsa_user_sgpr_count 2
  .amdhsa_user_sgpr_kernarg_segment_ptr 1
  .amdhsa_system_sgpr_workgroup_id_x 1
.end_amdhsa_kernel
```
